```python
import torch

def _softmax(x, axis=-1):
    return torch.softmax(x, dim=axis)

def _gelu(x):
    return torch.nn.functional.gelu(x, approximate='tanh')

def _silu(x):
    return torch.nn.functional.silu(x)

def _sigmoid(x):
    return torch.sigmoid(x)

def _layernorm(x, axis=-1, eps=1e-05):
    m = x.mean(dim=axis, keepdim=True)
    v = x.var(dim=axis, keepdim=True, unbiased=False)
    return (x - m) / torch.sqrt(v + eps)

def _scatter_add(tgt, idx, src, axis=0):
    return tgt.clone().index_add_(axis, idx, src)

def _segment_sum(src, seg, n):
    out = torch.zeros((n,) + src.shape[1:], dtype=src.dtype)
    return out.index_add_(0, seg, src)

def _pad(x, pw):
    flat = tuple((v for pair in reversed(pw) for v in pair))
    return torch.nn.functional.pad(x, flat)
kernel_name = 'adaLN_cond__sliding_block_cached__glu_gated_glu__decode'

def setup_inputs():

    _w = lambda a: (lambda t: t.to(torch.bfloat16) if t.is_floating_point() else t)(torch.as_tensor(a))

    def _A_setup():
        B, Sq, D = (8, 1, 448)
        Hq, Hkv, Sk, Dh = (16, 8, 8192, 256)
        assert Hq % Hkv == 0, (Hq, Hkv)
        return {'x': _w((lambda *s: torch.randn(*s, dtype=torch.bfloat16) * 0.05)(B, Sq, D)), 'k_cache': _w((lambda *s: torch.randn(*s, dtype=torch.bfloat16) * 3.2)(B, Hkv, Sk, Dh)), 'v_cache': _w((lambda *s: torch.randn(*s, dtype=torch.bfloat16) * 0.4)(B, Hkv, Sk, Dh)), 'wq': _w((lambda *s: torch.randn(*s, dtype=torch.bfloat16) * 3.2)(D, Hq * Dh) * D ** (-0.5)), 'wo': _w((lambda *s: torch.randn(*s, dtype=torch.bfloat16) * 0.4)(Hq * Dh, D) * (Hq * Dh) ** (-0.5))}
    _A_in = _A_setup()

    def _B_setup():
        B, S, D, F = (8, 1, 448, 1792)
        return {'x': _w((lambda *s: torch.randn(*s, dtype=torch.bfloat16) * 0.05)(B, S, D)), 'w_gate': _w((lambda *s: torch.randn(*s, dtype=torch.bfloat16) * 0.05)(D, F)), 'w_up': _w((lambda *s: torch.randn(*s, dtype=torch.bfloat16) * 0.05)(D, F)), 'w_down': _w((lambda *s: torch.randn(*s, dtype=torch.bfloat16) * 0.05)(F, D))}
    _B_in = _B_setup()
    return {'A_x': _A_in['x'], 'A_k_cache': _A_in['k_cache'], 'A_v_cache': _A_in['v_cache'], 'A_wq': _A_in['wq'], 'A_wo': _A_in['wo'], 'B_x': _B_in['x'], 'B_w_gate': _B_in['w_gate'], 'B_w_up': _B_in['w_up'], 'B_w_down': _B_in['w_down'], 'c': _w((lambda *s: torch.randn(*s, dtype=torch.bfloat16) * 0.1)(8, 448) * 8.0), 'w_mod': _w((lambda *s: torch.randn(*s, dtype=torch.bfloat16) * 0.1)(448, 6 * 448) * 448 ** (-0.5) * 8.0)}

def reference(A_x, A_k_cache, A_v_cache, A_wq, A_wo, B_x, B_w_gate, B_w_up, B_w_down, c, w_mod):

    def _A_ref(x, k_cache, v_cache, wq, wo):
        B, Sq, D = x.shape
        Hq, Dh = (16, 256)
        Hkv, Sk = (k_cache.shape[1], k_cache.shape[2])
        W = min(4096, max(256, Sk // 4))
        rep = Hq // Hkv
        q = (lambda x, *d: x.permute(*d))((x @ wq).reshape(B, Sq, Hq, Dh), 0, 2, 1, 3)
        k = (lambda x, n, axis: torch.repeat_interleave(x, n, dim=axis))(k_cache[:, :, Sk - W:, :], rep, axis=1)
        v = (lambda x, n, axis: torch.repeat_interleave(x, n, dim=axis))(v_cache[:, :, Sk - W:, :], rep, axis=1)
        scores = torch.einsum('bhqd,bhkd->bhqk', q, k) * Dh ** (-0.5)
        p = _softmax(scores, axis=-1)
        o = torch.einsum('bhqk,bhkd->bhqd', p, v)
        return (lambda x, *d: x.permute(*d))(o, 0, 2, 1, 3).reshape(B, Sq, Hq * Dh) @ wo

    def _B_ref(x, w_gate, w_up, w_down):
        g = torch.einsum('bsd,df->bsf', x, w_gate)
        u = torch.einsum('bsd,df->bsf', x, w_up)
        h = _sigmoid(g) * u
        return torch.einsum('bsf,fd->bsd', h, w_down)
    x = A_x
    mod = (_silu(c) @ w_mod).reshape(c.shape[0], 6, 1, -1)
    sa, ca, ga, sb, cb, gb = (mod[:, 0].clone(), mod[:, 1].clone(), mod[:, 2].clone(), mod[:, 3].clone(), mod[:, 4].clone(), mod[:, 5].clone())
    h = _layernorm(x, axis=-1) * (1 + ca) + sa
    x = x + ga * _A_ref(h, A_k_cache, A_v_cache, A_wq, A_wo)
    h = _layernorm(x, axis=-1) * (1 + cb) + sb
    x = x + gb * _B_ref(h, B_w_gate, B_w_up, B_w_down)
    return x
```

```asm
; @launch grid=(256,1,1) block=(1024,1,1) lds=155648
.amdgcn_target "amdgcn-amd-amdhsa--gfx950"
.text
.globl adaLN_cond__sliding_block_cached__glu_gated_glu__decode_kernel
.p2align 8
.type adaLN_cond__sliding_block_cached__glu_gated_glu__decode_kernel,@function
adaLN_cond__sliding_block_cached__glu_gated_glu__decode_kernel:
    s_cmp_ge_u32 s2, 256
    s_cbranch_scc1 L_end
    s_load_dwordx16 s[36:51], s[0:1], 0
    s_load_dwordx8 s[52:59], s[0:1], 64
    s_load_dwordx4 s[60:63], s[0:1], 96
    v_lshrrev_b32 v1, 6, v0
    v_and_b32 v0, 63, v0
    v_mov_b32 v2, 0
    v_readfirstlane_b32 s3, v1
    s_and_b32 s4, s2, 7
    s_bfe_u32 s5, s2, 0x30003
    s_lshr_b32 s6, s2, 6
    s_cmp_eq_u32 s6, 0
    s_cselect_b32 s28, 1, 2
    s_cmp_eq_u32 s6, 1
    s_cselect_b32 s28, 0, s28
    s_cmp_ge_u32 s4, 2
    s_cselect_b32 s28, 0, s28
    s_mov_b32 s64, 0x05040100
    s_mov_b32 s65, 0x07060302
    s_mov_b32 s66, 0xffff0000
    s_mov_b32 s67, 0x3db8aa3b
    s_cmp_ge_u32 s3, 8
    s_cbranch_scc1 L_notstream
L_stream:
    s_lshl_b32 s30, s5, 3
    s_add_u32 s30, s30, s4
    s_lshl_b32 s31, s30, 22
    s_add_u32 s31, s31, 0x300000
    v_bfe_u32 v3, v0, 1, 3
    v_lshlrev_b32 v1, 10, v3
    v_and_b32 v4, 1, v0
    v_lshl_add_u32 v1, v4, 4, v1
    v_and_b32 v3, 7, v0
    v_lshrrev_b32 v4, 4, v0
    v_lshl_add_u32 v1, v4, 5, v1
    v_lshrrev_b32 v4, 3, v0
    v_lshlrev_b32 v4, 12, v4
    v_lshl_add_u32 v14, v3, 4, v4
    s_lshl_b32 s32, s6, 15
    s_lshr_b32 s33, s3, 1
    s_lshl_b32 s33, s33, 13
    s_add_u32 s34, s32, s33
    s_and_b32 s33, s3, 1
    s_lshl_b32 s33, s33, 9
    s_add_u32 s68, s34, s33
    s_lshl_b32 s32, s6, 7
    s_lshl_b32 s33, s3, 15
    s_add_u32 s35, s32, s33
    s_lshl_b32 s33, s3, 13
    s_add_u32 s33, s33, 90112
    s_waitcnt lgkmcnt(0)
    s_add_u32 s8, s38, s31
    s_addc_u32 s9, s39, 0
    s_mov_b32 s10, 0x100000
    s_mov_b32 s11, 0x20000
    s_add_u32 s12, s40, s31
    s_addc_u32 s13, s41, 0
    s_mov_b32 s14, 0x100000
    s_mov_b32 s15, 0x20000
    s_add_u32 s69, s68, 131072
    s_add_u32 s70, s68, 262144
    s_add_u32 s71, s68, 393216
    s_add_u32 s72, s68, 524288
    s_add_u32 s73, s68, 655360
    s_add_u32 s74, s68, 786432
    s_add_u32 s75, s68, 917504
    s_cmp_eq_u32 s28, 1
    s_cbranch_scc1 L_st_hp
    buffer_load_dwordx4 v[32:35], v1, s[8:11], s68 offen offset:0 nt
    buffer_load_dwordx4 v[36:39], v1, s[8:11], s68 offen offset:128 nt
    buffer_load_dwordx4 v[40:43], v1, s[8:11], s68 offen offset:256 nt
    s_lshl_b32 s30, s4, 3
    s_add_u32 s30, s30, s5
    s_cmp_ge_u32 s4, 2
    s_cbranch_scc0 pr_1
    s_mul_i32 s29, s5, 6
    s_add_u32 s29, s29, s4
    s_add_u32 s29, s29, 14
    s_lshl_b32 s31, s6, 8
    s_add_u32 s31, s31, s29
    s_cmp_lt_u32 s31, 32
    s_cselect_b32 s79, 1, 0
    s_cmp_eq_u32 s5, 3
    s_cselect_b32 s31, 9, s6
    s_cmp_eq_u32 s31, 1
    s_cselect_b32 s29, s30, s29
    s_cselect_b32 s79, 2, s79
    s_branch pr_2
pr_1:
    s_lshl_b32 s29, s5, 1
    s_add_u32 s29, s29, s4
    s_cmp_eq_u32 s6, 0
    s_cselect_b32 s79, 1, 0
    s_cmp_eq_u32 s6, 2
    s_cselect_b32 s29, s30, s29
    s_cselect_b32 s79, 2, s79
    s_cmp_eq_u32 s6, 3
    s_cbranch_scc0 pr_2
    s_lshl_b32 s29, s30, 3
    s_add_u32 s29, s29, 19
    s_add_u32 s31, s30, 26
    s_cmp_lt_u32 s30, 6
    s_cselect_b32 s29, s29, s31
    s_cselect_b32 s79, 2, 1
pr_2:
    s_barrier
    s_cmp_lg_u32 s79, 0
    s_cbranch_scc1 L_st_q
    s_waitcnt vmcnt(2)
    buffer_load_dwordx4 v[44:47], v1, s[8:11], s68 offen offset:384 nt
    s_waitcnt vmcnt(2)
    buffer_load_dwordx4 v[48:51], v1, s[8:11], s69 offen offset:0 nt
    s_waitcnt vmcnt(2)
    buffer_load_dwordx4 v[52:55], v1, s[8:11], s69 offen offset:128 nt
    s_waitcnt vmcnt(2)
    buffer_load_dwordx4 v[56:59], v1, s[8:11], s69 offen offset:256 nt
    s_waitcnt vmcnt(2)
    buffer_load_dwordx4 v[60:63], v1, s[8:11], s69 offen offset:384 nt
    s_waitcnt vmcnt(2)
    buffer_load_dwordx4 v[64:67], v1, s[8:11], s70 offen offset:0 nt
    s_waitcnt vmcnt(2)
    buffer_load_dwordx4 v[68:71], v1, s[8:11], s70 offen offset:128 nt
    s_waitcnt vmcnt(2)
    buffer_load_dwordx4 v[72:75], v1, s[8:11], s70 offen offset:256 nt
    s_waitcnt vmcnt(2)
    buffer_load_dwordx4 v[76:79], v1, s[8:11], s70 offen offset:384 nt
    s_waitcnt vmcnt(2)
    buffer_load_dwordx4 v[80:83], v1, s[8:11], s71 offen offset:0 nt
    s_waitcnt vmcnt(2)
    buffer_load_dwordx4 v[84:87], v1, s[8:11], s71 offen offset:128 nt
    s_waitcnt vmcnt(2)
    buffer_load_dwordx4 v[88:91], v1, s[8:11], s71 offen offset:256 nt
    s_waitcnt vmcnt(2)
    buffer_load_dwordx4 v[92:95], v1, s[8:11], s71 offen offset:384 nt
    s_waitcnt vmcnt(2)
    buffer_load_dwordx4 v[96:99], v1, s[8:11], s72 offen offset:0 nt
    s_waitcnt vmcnt(2)
    buffer_load_dwordx4 v[100:103], v1, s[8:11], s72 offen offset:128 nt
    s_waitcnt vmcnt(2)
    buffer_load_dwordx4 v[104:107], v1, s[8:11], s72 offen offset:256 nt
    s_waitcnt vmcnt(2)
    buffer_load_dwordx4 v[108:111], v1, s[8:11], s72 offen offset:384 nt
    s_waitcnt vmcnt(2)
    buffer_load_dwordx4 v[112:115], v1, s[8:11], s73 offen offset:0 nt
    s_waitcnt vmcnt(2)
    buffer_load_dwordx4 v[116:119], v1, s[8:11], s73 offen offset:128 nt
    s_waitcnt vmcnt(2)
    buffer_load_dwordx4 v[120:123], v1, s[8:11], s73 offen offset:256 nt
    s_waitcnt vmcnt(2)
    buffer_load_dwordx4 v[124:127], v1, s[8:11], s73 offen offset:384 nt
    s_add_u32 m0, s33, 0
    s_waitcnt vmcnt(2)
    buffer_load_dwordx4 v1, s[8:11], s74 offen offset:0 nt lds
    s_add_u32 m0, s33, 896
    s_waitcnt vmcnt(2)
    buffer_load_dwordx4 v1, s[8:11], s74 offen offset:128 nt lds
    s_add_u32 m0, s33, 1792
    s_waitcnt vmcnt(2)
    buffer_load_dwordx4 v1, s[8:11], s74 offen offset:256 nt lds
    s_add_u32 m0, s33, 2688
    s_waitcnt vmcnt(2)
    buffer_load_dwordx4 v1, s[8:11], s74 offen offset:384 nt lds
    s_add_u32 m0, s33, 4096
    s_waitcnt vmcnt(2)
    buffer_load_dwordx4 v1, s[8:11], s75 offen offset:0 nt lds
    s_add_u32 m0, s33, 4992
    s_waitcnt vmcnt(2)
    buffer_load_dwordx4 v1, s[8:11], s75 offen offset:128 nt lds
    s_add_u32 m0, s33, 5888
    s_waitcnt vmcnt(2)
    buffer_load_dwordx4 v1, s[8:11], s75 offen offset:256 nt lds
    s_add_u32 m0, s33, 6784
    s_waitcnt vmcnt(2)
    buffer_load_dwordx4 v1, s[8:11], s75 offen offset:384 nt lds
    s_branch L_st_kdone
L_st_q:
    buffer_load_dwordx4 v[44:47], v1, s[8:11], s68 offen offset:384 nt
    s_waitcnt vmcnt(3)
    buffer_load_dwordx4 v[48:51], v1, s[8:11], s69 offen offset:0 nt
    s_waitcnt vmcnt(3)
    buffer_load_dwordx4 v[52:55], v1, s[8:11], s69 offen offset:128 nt
    s_waitcnt vmcnt(3)
    buffer_load_dwordx4 v[56:59], v1, s[8:11], s69 offen offset:256 nt
    s_waitcnt vmcnt(3)
    buffer_load_dwordx4 v[60:63], v1, s[8:11], s69 offen offset:384 nt
    s_waitcnt vmcnt(3)
    buffer_load_dwordx4 v[64:67], v1, s[8:11], s70 offen offset:0 nt
    s_waitcnt vmcnt(3)
    buffer_load_dwordx4 v[68:71], v1, s[8:11], s70 offen offset:128 nt
    s_waitcnt vmcnt(3)
    buffer_load_dwordx4 v[72:75], v1, s[8:11], s70 offen offset:256 nt
    s_waitcnt vmcnt(3)
    buffer_load_dwordx4 v[76:79], v1, s[8:11], s70 offen offset:384 nt
    s_waitcnt vmcnt(3)
    buffer_load_dwordx4 v[80:83], v1, s[8:11], s71 offen offset:0 nt
    s_waitcnt vmcnt(3)
    buffer_load_dwordx4 v[84:87], v1, s[8:11], s71 offen offset:128 nt
    s_waitcnt vmcnt(3)
    buffer_load_dwordx4 v[88:91], v1, s[8:11], s71 offen offset:256 nt
    s_waitcnt vmcnt(3)
    buffer_load_dwordx4 v[92:95], v1, s[8:11], s71 offen offset:384 nt
    s_waitcnt vmcnt(3)
    buffer_load_dwordx4 v[96:99], v1, s[8:11], s72 offen offset:0 nt
    s_waitcnt vmcnt(3)
    buffer_load_dwordx4 v[100:103], v1, s[8:11], s72 offen offset:128 nt
    s_waitcnt vmcnt(3)
    buffer_load_dwordx4 v[104:107], v1, s[8:11], s72 offen offset:256 nt
    s_waitcnt vmcnt(3)
    buffer_load_dwordx4 v[108:111], v1, s[8:11], s72 offen offset:384 nt
    s_waitcnt vmcnt(3)
    buffer_load_dwordx4 v[112:115], v1, s[8:11], s73 offen offset:0 nt
    s_waitcnt vmcnt(3)
    buffer_load_dwordx4 v[116:119], v1, s[8:11], s73 offen offset:128 nt
    s_waitcnt vmcnt(3)
    buffer_load_dwordx4 v[120:123], v1, s[8:11], s73 offen offset:256 nt
    s_waitcnt vmcnt(3)
    buffer_load_dwordx4 v[124:127], v1, s[8:11], s73 offen offset:384 nt
    s_add_u32 m0, s33, 0
    s_waitcnt vmcnt(3)
    buffer_load_dwordx4 v1, s[8:11], s74 offen offset:0 nt lds
    s_add_u32 m0, s33, 896
    s_waitcnt vmcnt(3)
    buffer_load_dwordx4 v1, s[8:11], s74 offen offset:128 nt lds
    s_add_u32 m0, s33, 1792
    s_waitcnt vmcnt(3)
    buffer_load_dwordx4 v1, s[8:11], s74 offen offset:256 nt lds
    s_add_u32 m0, s33, 2688
    s_waitcnt vmcnt(3)
    buffer_load_dwordx4 v1, s[8:11], s74 offen offset:384 nt lds
    s_add_u32 m0, s33, 4096
    s_waitcnt vmcnt(3)
    buffer_load_dwordx4 v1, s[8:11], s75 offen offset:0 nt lds
    s_add_u32 m0, s33, 4992
    s_waitcnt vmcnt(3)
    buffer_load_dwordx4 v1, s[8:11], s75 offen offset:128 nt lds
    s_add_u32 m0, s33, 5888
    s_waitcnt vmcnt(3)
    buffer_load_dwordx4 v1, s[8:11], s75 offen offset:256 nt lds
    s_add_u32 m0, s33, 6784
    s_waitcnt vmcnt(3)
    buffer_load_dwordx4 v1, s[8:11], s75 offen offset:384 nt lds
    s_branch L_st_kdone
L_st_hp:
    s_mov_b32 s79, 1
    s_barrier
spin_3:
    ds_read_b32 v3, v2 offset:8
    s_waitcnt lgkmcnt(0)
    v_readfirstlane_b32 s30, v3
    s_nop 0
    s_cmp_ge_u32 s30, 7
    s_cbranch_scc1 spind_4
    s_sleep 1
    s_branch spin_3
spind_4:
    buffer_load_dwordx4 v[32:35], v1, s[8:11], s68 offen offset:0 nt
    buffer_load_dwordx4 v[36:39], v1, s[8:11], s68 offen offset:128 nt
    buffer_load_dwordx4 v[40:43], v1, s[8:11], s68 offen offset:256 nt
    s_waitcnt vmcnt(2)
    buffer_load_dwordx4 v[44:47], v1, s[8:11], s68 offen offset:384 nt
    s_waitcnt vmcnt(2)
    buffer_load_dwordx4 v[48:51], v1, s[8:11], s69 offen offset:0 nt
    s_waitcnt vmcnt(2)
    buffer_load_dwordx4 v[52:55], v1, s[8:11], s69 offen offset:128 nt
    s_waitcnt vmcnt(2)
    buffer_load_dwordx4 v[56:59], v1, s[8:11], s69 offen offset:256 nt
    s_waitcnt vmcnt(2)
    buffer_load_dwordx4 v[60:63], v1, s[8:11], s69 offen offset:384 nt
    s_waitcnt vmcnt(2)
    buffer_load_dwordx4 v[64:67], v1, s[8:11], s70 offen offset:0 nt
    s_waitcnt vmcnt(2)
    buffer_load_dwordx4 v[68:71], v1, s[8:11], s70 offen offset:128 nt
    s_waitcnt vmcnt(2)
    buffer_load_dwordx4 v[72:75], v1, s[8:11], s70 offen offset:256 nt
    s_waitcnt vmcnt(2)
    buffer_load_dwordx4 v[76:79], v1, s[8:11], s70 offen offset:384 nt
    s_waitcnt vmcnt(2)
    buffer_load_dwordx4 v[80:83], v1, s[8:11], s71 offen offset:0 nt
    s_waitcnt vmcnt(2)
    buffer_load_dwordx4 v[84:87], v1, s[8:11], s71 offen offset:128 nt
    s_waitcnt vmcnt(2)
    buffer_load_dwordx4 v[88:91], v1, s[8:11], s71 offen offset:256 nt
    s_waitcnt vmcnt(2)
    buffer_load_dwordx4 v[92:95], v1, s[8:11], s71 offen offset:384 nt
    s_waitcnt vmcnt(2)
    buffer_load_dwordx4 v[96:99], v1, s[8:11], s72 offen offset:0 nt
    s_waitcnt vmcnt(2)
    buffer_load_dwordx4 v[100:103], v1, s[8:11], s72 offen offset:128 nt
    s_waitcnt vmcnt(2)
    buffer_load_dwordx4 v[104:107], v1, s[8:11], s72 offen offset:256 nt
    s_waitcnt vmcnt(2)
    buffer_load_dwordx4 v[108:111], v1, s[8:11], s72 offen offset:384 nt
    s_waitcnt vmcnt(2)
    buffer_load_dwordx4 v[112:115], v1, s[8:11], s73 offen offset:0 nt
    s_waitcnt vmcnt(2)
    buffer_load_dwordx4 v[116:119], v1, s[8:11], s73 offen offset:128 nt
    s_waitcnt vmcnt(2)
    buffer_load_dwordx4 v[120:123], v1, s[8:11], s73 offen offset:256 nt
    s_waitcnt vmcnt(2)
    buffer_load_dwordx4 v[124:127], v1, s[8:11], s73 offen offset:384 nt
    s_add_u32 m0, s33, 0
    s_waitcnt vmcnt(2)
    buffer_load_dwordx4 v1, s[8:11], s74 offen offset:0 nt lds
    s_add_u32 m0, s33, 896
    s_waitcnt vmcnt(2)
    buffer_load_dwordx4 v1, s[8:11], s74 offen offset:128 nt lds
    s_add_u32 m0, s33, 1792
    s_waitcnt vmcnt(2)
    buffer_load_dwordx4 v1, s[8:11], s74 offen offset:256 nt lds
    s_add_u32 m0, s33, 2688
    s_waitcnt vmcnt(2)
    buffer_load_dwordx4 v1, s[8:11], s74 offen offset:384 nt lds
    s_add_u32 m0, s33, 4096
    s_waitcnt vmcnt(2)
    buffer_load_dwordx4 v1, s[8:11], s75 offen offset:0 nt lds
    s_add_u32 m0, s33, 4992
    s_waitcnt vmcnt(2)
    buffer_load_dwordx4 v1, s[8:11], s75 offen offset:128 nt lds
    s_add_u32 m0, s33, 5888
    s_waitcnt vmcnt(2)
    buffer_load_dwordx4 v1, s[8:11], s75 offen offset:256 nt lds
    s_add_u32 m0, s33, 6784
    s_waitcnt vmcnt(2)
    buffer_load_dwordx4 v1, s[8:11], s75 offen offset:384 nt lds
L_st_kdone:
    s_mov_b32 s24, s62
    s_mov_b32 s25, s63
    s_mov_b32 s26, 0x200000
    s_mov_b32 s27, 0x20000
spin_5:
    ds_read_b32 v3, v2 offset:0
    s_waitcnt lgkmcnt(0)
    v_readfirstlane_b32 s30, v3
    s_nop 0
    s_cmp_ge_u32 s30, 1
    s_cbranch_scc1 spind_6
    s_sleep 1
    s_branch spin_5
spind_6:
    v_and_b32 v3, 1, v0
    v_lshlrev_b32 v3, 9, v3
    v_bfe_u32 v4, v0, 1, 1
    v_lshl_add_u32 v3, v4, 4, v3
    v_lshrrev_b32 v4, 4, v0
    v_lshl_add_u32 v3, v4, 5, v3
    ds_read_b128 v[16:19], v3 offset:4096
    ds_read_b128 v[20:23], v3 offset:4224
    ds_read_b128 v[24:27], v3 offset:4352
    ds_read_b128 v[28:31], v3 offset:4480
    s_waitcnt lgkmcnt(0)
    s_mov_b32 s72, s35
    s_add_u32 s73, s35, 262144
    s_add_u32 s74, s35, 524288
    s_add_u32 s75, s35, 786432
    s_waitcnt vmcnt(20)
    v_mfma_f32_16x16x32_bf16 v[4:7], v[16:19], v[64:67], 0
    v_mfma_f32_16x16x32_bf16 v[4:7], v[20:23], v[68:71], v[4:7]
    v_mfma_f32_16x16x32_bf16 v[4:7], v[24:27], v[72:75], v[4:7]
    v_mfma_f32_16x16x32_bf16 v[4:7], v[28:31], v[76:79], v[4:7]
    s_waitcnt vmcnt(16)
    v_mfma_f32_16x16x32_bf16 v[8:11], v[16:19], v[80:83], 0
    v_mfma_f32_16x16x32_bf16 v[8:11], v[20:23], v[84:87], v[8:11]
    v_mfma_f32_16x16x32_bf16 v[8:11], v[24:27], v[88:91], v[8:11]
    v_mfma_f32_16x16x32_bf16 v[8:11], v[28:31], v[92:95], v[8:11]
    s_nop 2
    v_add_f32_dpp v12, v6, v4 quad_perm:[1,1,3,3] row_mask:0x2 bank_mask:0xf
    v_add_f32_dpp v13, v7, v5 quad_perm:[1,1,3,3] row_mask:0x2 bank_mask:0xf
    s_cmp_eq_u32 s6, 3
    s_cbranch_scc1 L_v3
    s_cmp_lg_u32 s79, 0
    s_cbranch_scc1 L_vhp
    s_waitcnt vmcnt(2)
    buffer_load_dwordx4 v[64:67], v14, s[12:15], s72 offen offset:0 nt
    s_waitcnt vmcnt(29)
    v_mfma_f32_16x16x32_bf16 v[4:7], v[16:19], v[32:35], 0
    v_mfma_f32_16x16x32_bf16 v[4:7], v[20:23], v[36:39], v[4:7]
    v_mfma_f32_16x16x32_bf16 v[4:7], v[24:27], v[40:43], v[4:7]
    v_mfma_f32_16x16x32_bf16 v[4:7], v[28:31], v[44:47], v[4:7]
    v_add_f32_dpp v1, v8, v10 quad_perm:[0,0,2,2] row_mask:0x2 bank_mask:0xf
    v_add_f32_dpp v15, v9, v11 quad_perm:[0,0,2,2] row_mask:0x2 bank_mask:0xf
    s_waitcnt vmcnt(25)
    v_mfma_f32_16x16x32_bf16 v[8:11], v[16:19], v[48:51], 0
    v_mfma_f32_16x16x32_bf16 v[8:11], v[20:23], v[52:55], v[8:11]
    v_mfma_f32_16x16x32_bf16 v[8:11], v[24:27], v[56:59], v[8:11]
    v_mfma_f32_16x16x32_bf16 v[8:11], v[28:31], v[60:63], v[8:11]
    s_nop 0
    v_add_f32_dpp v12, v6, v4 quad_perm:[1,1,3,3] row_mask:0x1 bank_mask:0xf
    v_add_f32_dpp v13, v7, v5 quad_perm:[1,1,3,3] row_mask:0x1 bank_mask:0xf
    s_mov_b32 s101, s33
    s_waitcnt vmcnt(2)
    buffer_load_dwordx4 v[68:71], v14, s[12:15], s72 offen offset:512 nt
    s_waitcnt vmcnt(14)
    v_mfma_f32_16x16x32_bf16 v[4:7], v[16:19], v[96:99], 0
    v_mfma_f32_16x16x32_bf16 v[4:7], v[20:23], v[100:103], v[4:7]
    v_mfma_f32_16x16x32_bf16 v[4:7], v[24:27], v[104:107], v[4:7]
    v_mfma_f32_16x16x32_bf16 v[4:7], v[28:31], v[108:111], v[4:7]
    v_add_f32_dpp v1, v8, v10 quad_perm:[0,0,2,2] row_mask:0x1 bank_mask:0xf
    v_add_f32_dpp v15, v9, v11 quad_perm:[0,0,2,2] row_mask:0x1 bank_mask:0xf
    s_waitcnt vmcnt(10)
    v_mfma_f32_16x16x32_bf16 v[8:11], v[16:19], v[112:115], 0
    v_mfma_f32_16x16x32_bf16 v[8:11], v[20:23], v[116:119], v[8:11]
    v_mfma_f32_16x16x32_bf16 v[8:11], v[24:27], v[120:123], v[8:11]
    v_mfma_f32_16x16x32_bf16 v[8:11], v[28:31], v[124:127], v[8:11]
    s_nop 0
    v_add_f32_dpp v12, v6, v4 quad_perm:[1,1,3,3] row_mask:0x4 bank_mask:0xf
    v_add_f32_dpp v13, v7, v5 quad_perm:[1,1,3,3] row_mask:0x4 bank_mask:0xf
    s_waitcnt vmcnt(2)
    buffer_load_dwordx4 v[72:75], v14, s[12:15], s72 offen offset:1024 nt
    s_nop 2
    v_add_f32_dpp v1, v8, v10 quad_perm:[0,0,2,2] row_mask:0x4 bank_mask:0xf
    v_add_f32_dpp v15, v9, v11 quad_perm:[0,0,2,2] row_mask:0x4 bank_mask:0xf
    v_lshlrev_b32 v3, 4, v0
    v_add_u32 v3, s33, v3
    s_waitcnt vmcnt(3)
    ds_read_b128 v[96:99], v3 offset:0
    ds_read_b128 v[100:103], v3 offset:1024
    ds_read_b128 v[104:107], v3 offset:2048
    ds_read_b128 v[108:111], v3 offset:3072
    ds_read_b128 v[112:115], v3 offset:4096
    ds_read_b128 v[116:119], v3 offset:5120
    ds_read_b128 v[120:123], v3 offset:6144
    ds_read_b128 v[124:127], v3 offset:7168
    s_waitcnt lgkmcnt(4)
    v_mfma_f32_16x16x32_bf16 v[4:7], v[16:19], v[96:99], 0
    v_mfma_f32_16x16x32_bf16 v[4:7], v[20:23], v[100:103], v[4:7]
    v_mfma_f32_16x16x32_bf16 v[4:7], v[24:27], v[104:107], v[4:7]
    v_mfma_f32_16x16x32_bf16 v[4:7], v[28:31], v[108:111], v[4:7]
    s_waitcnt lgkmcnt(0)
    v_mfma_f32_16x16x32_bf16 v[8:11], v[16:19], v[112:115], 0
    v_mfma_f32_16x16x32_bf16 v[8:11], v[20:23], v[116:119], v[8:11]
    v_mfma_f32_16x16x32_bf16 v[8:11], v[24:27], v[120:123], v[8:11]
    v_mfma_f32_16x16x32_bf16 v[8:11], v[28:31], v[124:127], v[8:11]
    s_nop 2
    v_add_f32_dpp v12, v6, v4 quad_perm:[1,1,3,3] row_mask:0x8 bank_mask:0xf
    v_add_f32_dpp v13, v7, v5 quad_perm:[1,1,3,3] row_mask:0x8 bank_mask:0xf
    s_nop 2
    v_add_f32_dpp v1, v8, v10 quad_perm:[0,0,2,2] row_mask:0x8 bank_mask:0xf
    v_add_f32_dpp v15, v9, v11 quad_perm:[0,0,2,2] row_mask:0x8 bank_mask:0xf
    s_waitcnt vmcnt(2)
    buffer_load_dwordx4 v[76:79], v14, s[12:15], s72 offen offset:1536 nt
    s_mov_b32 s30, 0xaaaaaaaa
    s_mov_b32 s31, 0xaaaaaaaa
    v_cndmask_b32 v12, v12, v1, s[30:31]
    v_cndmask_b32 v13, v13, v15, s[30:31]
    v_lshlrev_b32 v15, 4, v0
    v_add_u32 v15, s101, v15
    v_cvt_pk_bf16_f32 v96, v12, v13
    s_lshl_b32 s30, s5, 3
    s_add_u32 s30, s30, s4
    s_lshl_b32 s31, s6, 3
    s_add_u32 s31, s31, s3
    v_min_u32 v96, -2, v96
    s_lshl_b32 s32, s30, 13
    s_lshl_b32 s33, s31, 8
    s_add_u32 s32, s32, s33
    s_add_u32 s32, s32, 131072
    v_and_b32 v3, 0x30, v0
    v_and_b32 v97, 1, v0
    v_lshl_add_u32 v3, v97, 3, v3
    v_bfe_u32 v97, v0, 1, 3
    v_add_lshl_u32 v3, v3, v97, 2
    buffer_store_dword v96, v3, s[24:27], s32 offen sc1
    v_lshlrev_b32 v12, 16, v96
    v_and_b32 v13, s66, v96
    v_mov_b32 v100, v12
    v_mov_b32 v101, v13
    s_nop 1
    v_permlane32_swap_b32 v100, v101
    v_max_f32 v100, v100, v101
    s_nop 1
    v_max_f32_dpp v100, v100, v100 row_ror:1 row_mask:0xf bank_mask:0xf
    s_nop 1
    v_max_f32_dpp v100, v100, v100 row_ror:2 row_mask:0xf bank_mask:0xf
    s_nop 1
    v_max_f32_dpp v100, v100, v100 row_ror:4 row_mask:0xf bank_mask:0xf
    s_nop 1
    v_max_f32_dpp v100, v100, v100 row_ror:8 row_mask:0xf bank_mask:0xf
    v_mov_b32 v3, v100
    s_nop 1
    v_permlane16_swap_b32 v3, v100
    v_max_f32 v100, v100, v3
    v_mov_b32 v102, v100
    s_nop 1
    v_permlane32_swap_b32 v100, v102
    s_lshl_b32 s32, s30, 9
    s_lshl_b32 s33, s31, 4
    s_add_u32 s32, s32, s33
    s_add_u32 s32, s32, 655360
    v_sub_f32 v101, v12, v100
    v_sub_f32 v103, v13, v102
    v_mul_f32 v101, s67, v101
    v_mul_f32 v103, s67, v103
    v_exp_f32 v101, v101
    v_exp_f32 v103, v103
    s_nop 1
    v_permlane32_swap_b32 v101, v103
    v_add_f32 v101, v101, v103
    s_nop 1
    v_add_f32_dpp v101, v101, v101 row_ror:1 row_mask:0xf bank_mask:0xf
    s_nop 1
    v_add_f32_dpp v101, v101, v101 row_ror:2 row_mask:0xf bank_mask:0xf
    s_nop 1
    v_add_f32_dpp v101, v101, v101 row_ror:4 row_mask:0xf bank_mask:0xf
    s_nop 1
    v_add_f32_dpp v101, v101, v101 row_ror:8 row_mask:0xf bank_mask:0xf
    v_mov_b32 v3, v101
    s_nop 1
    v_permlane16_swap_b32 v3, v101
    v_add_f32 v101, v101, v3
    v_mov_b32 v103, v101
    s_nop 1
    v_permlane32_swap_b32 v101, v103
    s_mov_b64 exec, 1
    buffer_store_dwordx4 v[100:103], v2, s[24:27], s32 offen sc1
    v_mov_b32 v3, 1
    ds_add_u32 v2, v3 offset:12
    s_mov_b64 exec, -1
    s_waitcnt vmcnt(2)
    buffer_load_dwordx4 v[80:83], v14, s[12:15], s72 offen offset:2048 nt
    s_waitcnt vmcnt(2)
    buffer_load_dwordx4 v[84:87], v14, s[12:15], s72 offen offset:2560 nt
    v_mov_b32 v16, 0
    v_mov_b32 v17, 0
    v_mov_b32 v18, 0
    v_mov_b32 v19, 0
    v_mov_b32 v20, 0
    v_mov_b32 v21, 0
    v_mov_b32 v22, 0
    v_mov_b32 v23, 0
    v_mov_b32 v24, 0
    v_mov_b32 v25, 0
    v_mov_b32 v26, 0
    v_mov_b32 v27, 0
    v_mov_b32 v28, 0
    v_mov_b32 v29, 0
    v_mov_b32 v30, 0
    v_mov_b32 v31, 0
    s_waitcnt vmcnt(2)
    buffer_load_dwordx4 v[88:91], v14, s[12:15], s72 offen offset:3072 nt
    s_waitcnt vmcnt(2)
    buffer_load_dwordx4 v[92:95], v14, s[12:15], s72 offen offset:3584 nt
    s_waitcnt vmcnt(2)
    buffer_load_dwordx4 v[32:35], v14, s[12:15], s73 offen offset:0 nt
    s_waitcnt vmcnt(2)
    buffer_load_dwordx4 v[36:39], v14, s[12:15], s73 offen offset:512 nt
    s_waitcnt vmcnt(2)
    buffer_load_dwordx4 v[40:43], v14, s[12:15], s73 offen offset:1024 nt
    v_mov_b32 v3, 1
    s_mov_b64 exec, 1
    ds_add_u32 v2, v3 offset:64
    s_mov_b64 exec, -1
    s_waitcnt vmcnt(2)
    buffer_load_dwordx4 v[44:47], v14, s[12:15], s73 offen offset:1536 nt
    s_waitcnt vmcnt(2)
    buffer_load_dwordx4 v[48:51], v14, s[12:15], s73 offen offset:2048 nt
    s_waitcnt vmcnt(2)
    buffer_load_dwordx4 v[52:55], v14, s[12:15], s73 offen offset:2560 nt
    s_waitcnt vmcnt(2)
    buffer_load_dwordx4 v[56:59], v14, s[12:15], s73 offen offset:3072 nt
    s_waitcnt vmcnt(2)
    buffer_load_dwordx4 v[60:63], v14, s[12:15], s73 offen offset:3584 nt
    s_add_u32 m0, s101, 0
    s_waitcnt vmcnt(2)
    buffer_load_dwordx4 v14, s[12:15], s74 offen offset:0 nt lds
    s_add_u32 m0, s101, 512
    s_waitcnt vmcnt(2)
    buffer_load_dwordx4 v14, s[12:15], s74 offen offset:512 nt lds
    s_add_u32 m0, s101, 1024
    s_waitcnt vmcnt(2)
    buffer_load_dwordx4 v14, s[12:15], s74 offen offset:1024 nt lds
    s_add_u32 m0, s101, 1536
    s_waitcnt vmcnt(2)
    buffer_load_dwordx4 v14, s[12:15], s74 offen offset:1536 nt lds
spin_7:
    ds_read_b32 v3, v2 offset:4
    s_waitcnt lgkmcnt(0)
    v_readfirstlane_b32 s30, v3
    s_nop 0
    s_cmp_ge_u32 s30, 1
    s_cbranch_scc1 spind_8
    s_sleep 1
    s_branch spin_7
spind_8:
    v_lshrrev_b32 v3, 4, v0
    v_bfe_u32 v4, v0, 1, 1
    v_lshlrev_b32 v3, 9, v3
    v_lshl_add_u32 v3, v4, 4, v3
    v_bfe_u32 v4, v0, 2, 2
    v_lshl_add_u32 v3, v4, 6, v3
    s_and_b32 s30, s3, 3
    s_lshl_b32 s30, s30, 11
    s_lshr_b32 s31, s3, 2
    s_lshl_b32 s31, s31, 5
    s_add_u32 s30, s30, s31
    v_add_u32 v3, s30, v3
    ds_read_b128 v[108:111], v3 offset:10240
    ds_read_b128 v[112:115], v3 offset:10496
    v_and_b32 v4, 1, v0
    v_lshlrev_b32 v5, 3, v4
    ds_read_b64 v[116:117], v5 offset:32
    v_mul_u32_u24 v4, 0x0202, v4
    v_lshlrev_b32 v4, 16, v4
    v_add_u32 v4, 0x05040c0c, v4
    s_waitcnt lgkmcnt(0)
    v_perm_b32 v108, v108, v108, v4
    v_perm_b32 v109, v109, v109, v4
    v_perm_b32 v110, v110, v110, v4
    v_perm_b32 v111, v111, v111, v4
    v_perm_b32 v112, v112, v112, v4
    v_perm_b32 v113, v113, v113, v4
    v_perm_b32 v114, v114, v114, v4
    v_perm_b32 v115, v115, v115, v4
    v_fma_f32 v108, v108, s67, -v116
    v_fma_f32 v109, v109, s67, -v116
    v_fma_f32 v110, v110, s67, -v116
    v_fma_f32 v111, v111, s67, -v116
    v_fma_f32 v112, v112, s67, -v116
    v_fma_f32 v113, v113, s67, -v116
    v_fma_f32 v114, v114, s67, -v116
    v_fma_f32 v115, v115, s67, -v116
    v_exp_f32 v108, v108
    v_exp_f32 v109, v109
    v_exp_f32 v110, v110
    v_exp_f32 v111, v111
    v_exp_f32 v112, v112
    v_exp_f32 v113, v113
    v_exp_f32 v114, v114
    v_exp_f32 v115, v115
    v_mul_f32 v108, v108, v117
    v_mul_f32 v109, v109, v117
    v_mul_f32 v110, v110, v117
    v_mul_f32 v111, v111, v117
    v_mul_f32 v112, v112, v117
    v_mul_f32 v113, v113, v117
    v_mul_f32 v114, v114, v117
    v_mul_f32 v115, v115, v117
    v_cvt_pk_bf16_f32 v96, v108, v112
    v_cvt_pk_bf16_f32 v97, v109, v113
    v_cvt_pk_bf16_f32 v98, v110, v114
    v_cvt_pk_bf16_f32 v99, v111, v115
    s_add_u32 m0, s101, 2048
    s_waitcnt vmcnt(1)
    buffer_load_dwordx4 v14, s[12:15], s74 offen offset:2048 nt lds
    v_mov_b32_dpp v16, v96 quad_perm:[0,1,2,3] row_mask:0xf bank_mask:0x1
    v_mov_b32_dpp v17, v97 quad_perm:[0,1,2,3] row_mask:0xf bank_mask:0x1
    v_mov_b32_dpp v18, v98 quad_perm:[0,1,2,3] row_mask:0xf bank_mask:0x1
    v_mov_b32_dpp v19, v99 quad_perm:[0,1,2,3] row_mask:0xf bank_mask:0x1
    v_mov_b32_dpp v20, v96 row_ror:4 row_mask:0xf bank_mask:0x2
    v_mov_b32_dpp v21, v97 row_ror:4 row_mask:0xf bank_mask:0x2
    v_mov_b32_dpp v22, v98 row_ror:4 row_mask:0xf bank_mask:0x2
    v_mov_b32_dpp v23, v99 row_ror:4 row_mask:0xf bank_mask:0x2
    v_mov_b32_dpp v24, v96 row_ror:8 row_mask:0xf bank_mask:0x4
    v_mov_b32_dpp v25, v97 row_ror:8 row_mask:0xf bank_mask:0x4
    v_mov_b32_dpp v26, v98 row_ror:8 row_mask:0xf bank_mask:0x4
    v_mov_b32_dpp v27, v99 row_ror:8 row_mask:0xf bank_mask:0x4
    v_mov_b32_dpp v28, v96 row_ror:12 row_mask:0xf bank_mask:0x8
    v_mov_b32_dpp v29, v97 row_ror:12 row_mask:0xf bank_mask:0x8
    v_mov_b32_dpp v30, v98 row_ror:12 row_mask:0xf bank_mask:0x8
    v_mov_b32_dpp v31, v99 row_ror:12 row_mask:0xf bank_mask:0x8
    s_waitcnt vmcnt(13)
    v_perm_b32 v108, v68, v64, s64
    v_perm_b32 v109, v76, v72, s64
    v_perm_b32 v110, v84, v80, s64
    v_perm_b32 v111, v92, v88, s64
    s_nop 1
    v_mfma_f32_16x16x32_bf16 v[100:103], v[16:19], v[108:111], 0
    v_perm_b32 v112, v68, v64, s65
    v_perm_b32 v113, v76, v72, s65
    v_perm_b32 v114, v84, v80, s65
    v_perm_b32 v115, v92, v88, s65
    s_nop 1
    v_mfma_f32_16x16x32_bf16 v[100:103], v[20:23], v[112:115], v[100:103]
    v_perm_b32 v116, v69, v65, s64
    v_perm_b32 v117, v77, v73, s64
    v_perm_b32 v118, v85, v81, s64
    v_perm_b32 v119, v93, v89, s64
    s_nop 1
    v_mfma_f32_16x16x32_bf16 v[100:103], v[24:27], v[116:119], v[100:103]
    s_add_u32 m0, s101, 2560
    s_waitcnt vmcnt(1)
    buffer_load_dwordx4 v14, s[12:15], s74 offen offset:2560 nt lds
    v_perm_b32 v120, v69, v65, s65
    v_perm_b32 v121, v77, v73, s65
    v_perm_b32 v122, v85, v81, s65
    v_perm_b32 v123, v93, v89, s65
    s_nop 1
    v_mfma_f32_16x16x32_bf16 v[100:103], v[28:31], v[120:123], v[100:103]
    v_perm_b32 v108, v70, v66, s64
    v_perm_b32 v109, v78, v74, s64
    v_perm_b32 v110, v86, v82, s64
    v_perm_b32 v111, v94, v90, s64
    s_nop 1
    v_mfma_f32_16x16x32_bf16 v[104:107], v[16:19], v[108:111], 0
    v_perm_b32 v112, v70, v66, s65
    v_perm_b32 v113, v78, v74, s65
    v_perm_b32 v114, v86, v82, s65
    v_perm_b32 v115, v94, v90, s65
    s_nop 1
    v_mfma_f32_16x16x32_bf16 v[104:107], v[20:23], v[112:115], v[104:107]
    v_perm_b32 v116, v71, v67, s64
    v_perm_b32 v117, v79, v75, s64
    v_perm_b32 v118, v87, v83, s64
    v_perm_b32 v119, v95, v91, s64
    s_nop 1
    v_mfma_f32_16x16x32_bf16 v[104:107], v[24:27], v[116:119], v[104:107]
    v_perm_b32 v120, v71, v67, s65
    v_perm_b32 v121, v79, v75, s65
    v_perm_b32 v122, v87, v83, s65
    v_perm_b32 v123, v95, v91, s65
    s_nop 1
    v_mfma_f32_16x16x32_bf16 v[104:107], v[28:31], v[120:123], v[104:107]
    s_add_u32 m0, s101, 3072
    s_waitcnt vmcnt(1)
    buffer_load_dwordx4 v14, s[12:15], s74 offen offset:3072 nt lds
    s_add_u32 m0, s101, 3584
    s_waitcnt vmcnt(1)
    buffer_load_dwordx4 v14, s[12:15], s74 offen offset:3584 nt lds
    s_waitcnt vmcnt(1)
    buffer_load_dwordx4 v[64:67], v14, s[12:15], s75 offen offset:0 nt
    v_mov_b32_dpp v16, v96 row_ror:12 row_mask:0xf bank_mask:0x1
    v_mov_b32_dpp v17, v97 row_ror:12 row_mask:0xf bank_mask:0x1
    v_mov_b32_dpp v18, v98 row_ror:12 row_mask:0xf bank_mask:0x1
    v_mov_b32_dpp v19, v99 row_ror:12 row_mask:0xf bank_mask:0x1
    v_mov_b32_dpp v20, v96 quad_perm:[0,1,2,3] row_mask:0xf bank_mask:0x2
    v_mov_b32_dpp v21, v97 quad_perm:[0,1,2,3] row_mask:0xf bank_mask:0x2
    v_mov_b32_dpp v22, v98 quad_perm:[0,1,2,3] row_mask:0xf bank_mask:0x2
    v_mov_b32_dpp v23, v99 quad_perm:[0,1,2,3] row_mask:0xf bank_mask:0x2
    v_mov_b32_dpp v24, v96 row_ror:4 row_mask:0xf bank_mask:0x4
    v_mov_b32_dpp v25, v97 row_ror:4 row_mask:0xf bank_mask:0x4
    v_mov_b32_dpp v26, v98 row_ror:4 row_mask:0xf bank_mask:0x4
    v_mov_b32_dpp v27, v99 row_ror:4 row_mask:0xf bank_mask:0x4
    v_mov_b32_dpp v28, v96 row_ror:8 row_mask:0xf bank_mask:0x8
    v_mov_b32_dpp v29, v97 row_ror:8 row_mask:0xf bank_mask:0x8
    v_mov_b32_dpp v30, v98 row_ror:8 row_mask:0xf bank_mask:0x8
    v_mov_b32_dpp v31, v99 row_ror:8 row_mask:0xf bank_mask:0x8
    s_waitcnt vmcnt(9)
    v_perm_b32 v108, v36, v32, s64
    v_perm_b32 v109, v44, v40, s64
    v_perm_b32 v110, v52, v48, s64
    v_perm_b32 v111, v60, v56, s64
    s_nop 1
    v_mfma_f32_16x16x32_bf16 v[100:103], v[16:19], v[108:111], v[100:103]
    v_perm_b32 v112, v36, v32, s65
    v_perm_b32 v113, v44, v40, s65
    v_perm_b32 v114, v52, v48, s65
    v_perm_b32 v115, v60, v56, s65
    s_nop 1
    v_mfma_f32_16x16x32_bf16 v[100:103], v[20:23], v[112:115], v[100:103]
    v_perm_b32 v116, v37, v33, s64
    v_perm_b32 v117, v45, v41, s64
    v_perm_b32 v118, v53, v49, s64
    v_perm_b32 v119, v61, v57, s64
    s_nop 1
    v_mfma_f32_16x16x32_bf16 v[100:103], v[24:27], v[116:119], v[100:103]
    v_perm_b32 v120, v37, v33, s65
    v_perm_b32 v121, v45, v41, s65
    v_perm_b32 v122, v53, v49, s65
    v_perm_b32 v123, v61, v57, s65
    s_nop 1
    v_mfma_f32_16x16x32_bf16 v[100:103], v[28:31], v[120:123], v[100:103]
    s_waitcnt vmcnt(1)
    buffer_load_dwordx4 v[68:71], v14, s[12:15], s75 offen offset:512 nt
    v_perm_b32 v108, v38, v34, s64
    v_perm_b32 v109, v46, v42, s64
    v_perm_b32 v110, v54, v50, s64
    v_perm_b32 v111, v62, v58, s64
    s_nop 1
    v_mfma_f32_16x16x32_bf16 v[104:107], v[16:19], v[108:111], v[104:107]
    v_perm_b32 v112, v38, v34, s65
    v_perm_b32 v113, v46, v42, s65
    v_perm_b32 v114, v54, v50, s65
    v_perm_b32 v115, v62, v58, s65
    s_nop 1
    v_mfma_f32_16x16x32_bf16 v[104:107], v[20:23], v[112:115], v[104:107]
    v_perm_b32 v116, v39, v35, s64
    v_perm_b32 v117, v47, v43, s64
    v_perm_b32 v118, v55, v51, s64
    v_perm_b32 v119, v63, v59, s64
    s_nop 1
    v_mfma_f32_16x16x32_bf16 v[104:107], v[24:27], v[116:119], v[104:107]
    v_perm_b32 v120, v39, v35, s65
    v_perm_b32 v121, v47, v43, s65
    v_perm_b32 v122, v55, v51, s65
    v_perm_b32 v123, v63, v59, s65
    s_nop 1
    v_mfma_f32_16x16x32_bf16 v[104:107], v[28:31], v[120:123], v[104:107]
    s_waitcnt vmcnt(1)
    buffer_load_dwordx4 v[72:75], v14, s[12:15], s75 offen offset:1024 nt
    s_waitcnt vmcnt(1)
    buffer_load_dwordx4 v[76:79], v14, s[12:15], s75 offen offset:1536 nt
    s_waitcnt vmcnt(4)
    ds_read_b128 v[32:35], v15 offset:0
    ds_read_b128 v[36:39], v15 offset:1024
    ds_read_b128 v[40:43], v15 offset:2048
    ds_read_b128 v[44:47], v15 offset:3072
    ds_read_b128 v[48:51], v15 offset:4096
    ds_read_b128 v[52:55], v15 offset:5120
    ds_read_b128 v[56:59], v15 offset:6144
    ds_read_b128 v[60:63], v15 offset:7168
    v_mov_b32_dpp v16, v96 row_ror:8 row_mask:0xf bank_mask:0x1
    v_mov_b32_dpp v17, v97 row_ror:8 row_mask:0xf bank_mask:0x1
    v_mov_b32_dpp v18, v98 row_ror:8 row_mask:0xf bank_mask:0x1
    v_mov_b32_dpp v19, v99 row_ror:8 row_mask:0xf bank_mask:0x1
    v_mov_b32_dpp v20, v96 row_ror:12 row_mask:0xf bank_mask:0x2
    v_mov_b32_dpp v21, v97 row_ror:12 row_mask:0xf bank_mask:0x2
    v_mov_b32_dpp v22, v98 row_ror:12 row_mask:0xf bank_mask:0x2
    v_mov_b32_dpp v23, v99 row_ror:12 row_mask:0xf bank_mask:0x2
    v_mov_b32_dpp v24, v96 quad_perm:[0,1,2,3] row_mask:0xf bank_mask:0x4
    v_mov_b32_dpp v25, v97 quad_perm:[0,1,2,3] row_mask:0xf bank_mask:0x4
    v_mov_b32_dpp v26, v98 quad_perm:[0,1,2,3] row_mask:0xf bank_mask:0x4
    v_mov_b32_dpp v27, v99 quad_perm:[0,1,2,3] row_mask:0xf bank_mask:0x4
    v_mov_b32_dpp v28, v96 row_ror:4 row_mask:0xf bank_mask:0x8
    v_mov_b32_dpp v29, v97 row_ror:4 row_mask:0xf bank_mask:0x8
    v_mov_b32_dpp v30, v98 row_ror:4 row_mask:0xf bank_mask:0x8
    v_mov_b32_dpp v31, v99 row_ror:4 row_mask:0xf bank_mask:0x8
    s_waitcnt lgkmcnt(0)
    s_waitcnt vmcnt(1)
    buffer_load_dwordx4 v[80:83], v14, s[12:15], s75 offen offset:2048 nt
    v_perm_b32 v108, v36, v32, s64
    v_perm_b32 v109, v44, v40, s64
    v_perm_b32 v110, v52, v48, s64
    v_perm_b32 v111, v60, v56, s64
    s_nop 1
    v_mfma_f32_16x16x32_bf16 v[100:103], v[16:19], v[108:111], v[100:103]
    v_perm_b32 v112, v36, v32, s65
    v_perm_b32 v113, v44, v40, s65
    v_perm_b32 v114, v52, v48, s65
    v_perm_b32 v115, v60, v56, s65
    s_nop 1
    v_mfma_f32_16x16x32_bf16 v[100:103], v[20:23], v[112:115], v[100:103]
    v_perm_b32 v116, v37, v33, s64
    v_perm_b32 v117, v45, v41, s64
    v_perm_b32 v118, v53, v49, s64
    v_perm_b32 v119, v61, v57, s64
    s_nop 1
    v_mfma_f32_16x16x32_bf16 v[100:103], v[24:27], v[116:119], v[100:103]
    v_perm_b32 v120, v37, v33, s65
    v_perm_b32 v121, v45, v41, s65
    v_perm_b32 v122, v53, v49, s65
    v_perm_b32 v123, v61, v57, s65
    s_nop 1
    v_mfma_f32_16x16x32_bf16 v[100:103], v[28:31], v[120:123], v[100:103]
    s_waitcnt vmcnt(1)
    buffer_load_dwordx4 v[84:87], v14, s[12:15], s75 offen offset:2560 nt
    v_perm_b32 v108, v38, v34, s64
    v_perm_b32 v109, v46, v42, s64
    v_perm_b32 v110, v54, v50, s64
    v_perm_b32 v111, v62, v58, s64
    s_nop 1
    v_mfma_f32_16x16x32_bf16 v[104:107], v[16:19], v[108:111], v[104:107]
    v_perm_b32 v112, v38, v34, s65
    v_perm_b32 v113, v46, v42, s65
    v_perm_b32 v114, v54, v50, s65
    v_perm_b32 v115, v62, v58, s65
    s_nop 1
    v_mfma_f32_16x16x32_bf16 v[104:107], v[20:23], v[112:115], v[104:107]
    v_perm_b32 v116, v39, v35, s64
    v_perm_b32 v117, v47, v43, s64
    v_perm_b32 v118, v55, v51, s64
    v_perm_b32 v119, v63, v59, s64
    s_nop 1
    v_mfma_f32_16x16x32_bf16 v[104:107], v[24:27], v[116:119], v[104:107]
    v_perm_b32 v120, v39, v35, s65
    v_perm_b32 v121, v47, v43, s65
    v_perm_b32 v122, v55, v51, s65
    v_perm_b32 v123, v63, v59, s65
    s_nop 1
    v_mfma_f32_16x16x32_bf16 v[104:107], v[28:31], v[120:123], v[104:107]
    s_waitcnt vmcnt(1)
    buffer_load_dwordx4 v[88:91], v14, s[12:15], s75 offen offset:3072 nt
    s_waitcnt vmcnt(1)
    buffer_load_dwordx4 v[92:95], v14, s[12:15], s75 offen offset:3584 nt
    v_mov_b32 v3, 1
    s_mov_b64 exec, 1
    ds_add_u32 v2, v3 offset:68
    s_mov_b64 exec, -1
    s_branch L_vlast
L_vhp:
    s_waitcnt vmcnt(3)
    buffer_load_dwordx4 v[64:67], v14, s[12:15], s72 offen offset:0 nt
    s_waitcnt vmcnt(29)
    v_mfma_f32_16x16x32_bf16 v[4:7], v[16:19], v[32:35], 0
    v_mfma_f32_16x16x32_bf16 v[4:7], v[20:23], v[36:39], v[4:7]
    v_mfma_f32_16x16x32_bf16 v[4:7], v[24:27], v[40:43], v[4:7]
    v_mfma_f32_16x16x32_bf16 v[4:7], v[28:31], v[44:47], v[4:7]
    v_add_f32_dpp v1, v8, v10 quad_perm:[0,0,2,2] row_mask:0x2 bank_mask:0xf
    v_add_f32_dpp v15, v9, v11 quad_perm:[0,0,2,2] row_mask:0x2 bank_mask:0xf
    s_waitcnt vmcnt(25)
    v_mfma_f32_16x16x32_bf16 v[8:11], v[16:19], v[48:51], 0
    v_mfma_f32_16x16x32_bf16 v[8:11], v[20:23], v[52:55], v[8:11]
    v_mfma_f32_16x16x32_bf16 v[8:11], v[24:27], v[56:59], v[8:11]
    v_mfma_f32_16x16x32_bf16 v[8:11], v[28:31], v[60:63], v[8:11]
    s_nop 0
    v_add_f32_dpp v12, v6, v4 quad_perm:[1,1,3,3] row_mask:0x1 bank_mask:0xf
    v_add_f32_dpp v13, v7, v5 quad_perm:[1,1,3,3] row_mask:0x1 bank_mask:0xf
    s_mov_b32 s101, s33
    s_waitcnt vmcnt(3)
    buffer_load_dwordx4 v[68:71], v14, s[12:15], s72 offen offset:512 nt
    s_waitcnt vmcnt(14)
    v_mfma_f32_16x16x32_bf16 v[4:7], v[16:19], v[96:99], 0
    v_mfma_f32_16x16x32_bf16 v[4:7], v[20:23], v[100:103], v[4:7]
    v_mfma_f32_16x16x32_bf16 v[4:7], v[24:27], v[104:107], v[4:7]
    v_mfma_f32_16x16x32_bf16 v[4:7], v[28:31], v[108:111], v[4:7]
    v_add_f32_dpp v1, v8, v10 quad_perm:[0,0,2,2] row_mask:0x1 bank_mask:0xf
    v_add_f32_dpp v15, v9, v11 quad_perm:[0,0,2,2] row_mask:0x1 bank_mask:0xf
    s_waitcnt vmcnt(10)
    v_mfma_f32_16x16x32_bf16 v[8:11], v[16:19], v[112:115], 0
    v_mfma_f32_16x16x32_bf16 v[8:11], v[20:23], v[116:119], v[8:11]
    v_mfma_f32_16x16x32_bf16 v[8:11], v[24:27], v[120:123], v[8:11]
    v_mfma_f32_16x16x32_bf16 v[8:11], v[28:31], v[124:127], v[8:11]
    s_nop 0
    v_add_f32_dpp v12, v6, v4 quad_perm:[1,1,3,3] row_mask:0x4 bank_mask:0xf
    v_add_f32_dpp v13, v7, v5 quad_perm:[1,1,3,3] row_mask:0x4 bank_mask:0xf
    s_waitcnt vmcnt(3)
    buffer_load_dwordx4 v[72:75], v14, s[12:15], s72 offen offset:1024 nt
    s_nop 2
    v_add_f32_dpp v1, v8, v10 quad_perm:[0,0,2,2] row_mask:0x4 bank_mask:0xf
    v_add_f32_dpp v15, v9, v11 quad_perm:[0,0,2,2] row_mask:0x4 bank_mask:0xf
    v_lshlrev_b32 v3, 4, v0
    v_add_u32 v3, s33, v3
    s_waitcnt vmcnt(3)
    ds_read_b128 v[96:99], v3 offset:0
    ds_read_b128 v[100:103], v3 offset:1024
    ds_read_b128 v[104:107], v3 offset:2048
    ds_read_b128 v[108:111], v3 offset:3072
    ds_read_b128 v[112:115], v3 offset:4096
    ds_read_b128 v[116:119], v3 offset:5120
    ds_read_b128 v[120:123], v3 offset:6144
    ds_read_b128 v[124:127], v3 offset:7168
    s_waitcnt lgkmcnt(4)
    v_mfma_f32_16x16x32_bf16 v[4:7], v[16:19], v[96:99], 0
    v_mfma_f32_16x16x32_bf16 v[4:7], v[20:23], v[100:103], v[4:7]
    v_mfma_f32_16x16x32_bf16 v[4:7], v[24:27], v[104:107], v[4:7]
    v_mfma_f32_16x16x32_bf16 v[4:7], v[28:31], v[108:111], v[4:7]
    s_waitcnt lgkmcnt(0)
    v_mfma_f32_16x16x32_bf16 v[8:11], v[16:19], v[112:115], 0
    v_mfma_f32_16x16x32_bf16 v[8:11], v[20:23], v[116:119], v[8:11]
    v_mfma_f32_16x16x32_bf16 v[8:11], v[24:27], v[120:123], v[8:11]
    v_mfma_f32_16x16x32_bf16 v[8:11], v[28:31], v[124:127], v[8:11]
    s_nop 2
    v_add_f32_dpp v12, v6, v4 quad_perm:[1,1,3,3] row_mask:0x8 bank_mask:0xf
    v_add_f32_dpp v13, v7, v5 quad_perm:[1,1,3,3] row_mask:0x8 bank_mask:0xf
    s_nop 2
    v_add_f32_dpp v1, v8, v10 quad_perm:[0,0,2,2] row_mask:0x8 bank_mask:0xf
    v_add_f32_dpp v15, v9, v11 quad_perm:[0,0,2,2] row_mask:0x8 bank_mask:0xf
    s_waitcnt vmcnt(3)
    buffer_load_dwordx4 v[76:79], v14, s[12:15], s72 offen offset:1536 nt
    s_mov_b32 s30, 0xaaaaaaaa
    s_mov_b32 s31, 0xaaaaaaaa
    v_cndmask_b32 v12, v12, v1, s[30:31]
    v_cndmask_b32 v13, v13, v15, s[30:31]
    v_lshlrev_b32 v15, 4, v0
    v_add_u32 v15, s101, v15
    v_cvt_pk_bf16_f32 v96, v12, v13
    s_lshl_b32 s30, s5, 3
    s_add_u32 s30, s30, s4
    s_lshl_b32 s31, s6, 3
    s_add_u32 s31, s31, s3
    v_min_u32 v96, -2, v96
    s_lshl_b32 s32, s30, 13
    s_lshl_b32 s33, s31, 8
    s_add_u32 s32, s32, s33
    s_add_u32 s32, s32, 131072
    v_and_b32 v3, 0x30, v0
    v_and_b32 v97, 1, v0
    v_lshl_add_u32 v3, v97, 3, v3
    v_bfe_u32 v97, v0, 1, 3
    v_add_lshl_u32 v3, v3, v97, 2
    buffer_store_dword v96, v3, s[24:27], s32 offen sc1
    v_lshlrev_b32 v12, 16, v96
    v_and_b32 v13, s66, v96
    v_mov_b32 v100, v12
    v_mov_b32 v101, v13
    s_nop 1
    v_permlane32_swap_b32 v100, v101
    v_max_f32 v100, v100, v101
    s_nop 1
    v_max_f32_dpp v100, v100, v100 row_ror:1 row_mask:0xf bank_mask:0xf
    s_nop 1
    v_max_f32_dpp v100, v100, v100 row_ror:2 row_mask:0xf bank_mask:0xf
    s_nop 1
    v_max_f32_dpp v100, v100, v100 row_ror:4 row_mask:0xf bank_mask:0xf
    s_nop 1
    v_max_f32_dpp v100, v100, v100 row_ror:8 row_mask:0xf bank_mask:0xf
    v_mov_b32 v3, v100
    s_nop 1
    v_permlane16_swap_b32 v3, v100
    v_max_f32 v100, v100, v3
    v_mov_b32 v102, v100
    s_nop 1
    v_permlane32_swap_b32 v100, v102
    s_lshl_b32 s32, s30, 9
    s_lshl_b32 s33, s31, 4
    s_add_u32 s32, s32, s33
    s_add_u32 s32, s32, 655360
    v_sub_f32 v101, v12, v100
    v_sub_f32 v103, v13, v102
    v_mul_f32 v101, s67, v101
    v_mul_f32 v103, s67, v103
    v_exp_f32 v101, v101
    v_exp_f32 v103, v103
    s_nop 1
    v_permlane32_swap_b32 v101, v103
    v_add_f32 v101, v101, v103
    s_nop 1
    v_add_f32_dpp v101, v101, v101 row_ror:1 row_mask:0xf bank_mask:0xf
    s_nop 1
    v_add_f32_dpp v101, v101, v101 row_ror:2 row_mask:0xf bank_mask:0xf
    s_nop 1
    v_add_f32_dpp v101, v101, v101 row_ror:4 row_mask:0xf bank_mask:0xf
    s_nop 1
    v_add_f32_dpp v101, v101, v101 row_ror:8 row_mask:0xf bank_mask:0xf
    v_mov_b32 v3, v101
    s_nop 1
    v_permlane16_swap_b32 v3, v101
    v_add_f32 v101, v101, v3
    v_mov_b32 v103, v101
    s_nop 1
    v_permlane32_swap_b32 v101, v103
    s_mov_b64 exec, 1
    buffer_store_dwordx4 v[100:103], v2, s[24:27], s32 offen sc1
    v_mov_b32 v3, 1
    ds_add_u32 v2, v3 offset:12
    s_mov_b64 exec, -1
    s_waitcnt vmcnt(3)
    buffer_load_dwordx4 v[80:83], v14, s[12:15], s72 offen offset:2048 nt
    s_waitcnt vmcnt(3)
    buffer_load_dwordx4 v[84:87], v14, s[12:15], s72 offen offset:2560 nt
    v_mov_b32 v16, 0
    v_mov_b32 v17, 0
    v_mov_b32 v18, 0
    v_mov_b32 v19, 0
    v_mov_b32 v20, 0
    v_mov_b32 v21, 0
    v_mov_b32 v22, 0
    v_mov_b32 v23, 0
    v_mov_b32 v24, 0
    v_mov_b32 v25, 0
    v_mov_b32 v26, 0
    v_mov_b32 v27, 0
    v_mov_b32 v28, 0
    v_mov_b32 v29, 0
    v_mov_b32 v30, 0
    v_mov_b32 v31, 0
    s_waitcnt vmcnt(3)
    buffer_load_dwordx4 v[88:91], v14, s[12:15], s72 offen offset:3072 nt
    s_waitcnt vmcnt(3)
    buffer_load_dwordx4 v[92:95], v14, s[12:15], s72 offen offset:3584 nt
    s_waitcnt vmcnt(3)
    buffer_load_dwordx4 v[32:35], v14, s[12:15], s73 offen offset:0 nt
    s_waitcnt vmcnt(3)
    buffer_load_dwordx4 v[36:39], v14, s[12:15], s73 offen offset:512 nt
    s_waitcnt vmcnt(3)
    buffer_load_dwordx4 v[40:43], v14, s[12:15], s73 offen offset:1024 nt
    v_mov_b32 v3, 1
    s_mov_b64 exec, 1
    ds_add_u32 v2, v3 offset:64
    s_mov_b64 exec, -1
    s_waitcnt vmcnt(3)
    buffer_load_dwordx4 v[44:47], v14, s[12:15], s73 offen offset:1536 nt
    s_waitcnt vmcnt(3)
    buffer_load_dwordx4 v[48:51], v14, s[12:15], s73 offen offset:2048 nt
    s_waitcnt vmcnt(3)
    buffer_load_dwordx4 v[52:55], v14, s[12:15], s73 offen offset:2560 nt
    s_waitcnt vmcnt(3)
    buffer_load_dwordx4 v[56:59], v14, s[12:15], s73 offen offset:3072 nt
    s_waitcnt vmcnt(3)
    buffer_load_dwordx4 v[60:63], v14, s[12:15], s73 offen offset:3584 nt
    s_add_u32 m0, s101, 0
    s_waitcnt vmcnt(3)
    buffer_load_dwordx4 v14, s[12:15], s74 offen offset:0 nt lds
    s_add_u32 m0, s101, 512
    s_waitcnt vmcnt(3)
    buffer_load_dwordx4 v14, s[12:15], s74 offen offset:512 nt lds
    s_add_u32 m0, s101, 1024
    s_waitcnt vmcnt(3)
    buffer_load_dwordx4 v14, s[12:15], s74 offen offset:1024 nt lds
    s_add_u32 m0, s101, 1536
    s_waitcnt vmcnt(3)
    buffer_load_dwordx4 v14, s[12:15], s74 offen offset:1536 nt lds
spin_9:
    ds_read_b32 v3, v2 offset:4
    s_waitcnt lgkmcnt(0)
    v_readfirstlane_b32 s30, v3
    s_nop 0
    s_cmp_ge_u32 s30, 1
    s_cbranch_scc1 spind_10
    s_sleep 1
    s_branch spin_9
spind_10:
    v_lshrrev_b32 v3, 4, v0
    v_bfe_u32 v4, v0, 1, 1
    v_lshlrev_b32 v3, 9, v3
    v_lshl_add_u32 v3, v4, 4, v3
    v_bfe_u32 v4, v0, 2, 2
    v_lshl_add_u32 v3, v4, 6, v3
    s_and_b32 s30, s3, 3
    s_lshl_b32 s30, s30, 11
    s_lshr_b32 s31, s3, 2
    s_lshl_b32 s31, s31, 5
    s_add_u32 s30, s30, s31
    v_add_u32 v3, s30, v3
    ds_read_b128 v[108:111], v3 offset:10240
    ds_read_b128 v[112:115], v3 offset:10496
    v_and_b32 v4, 1, v0
    v_lshlrev_b32 v5, 3, v4
    ds_read_b64 v[116:117], v5 offset:32
    v_mul_u32_u24 v4, 0x0202, v4
    v_lshlrev_b32 v4, 16, v4
    v_add_u32 v4, 0x05040c0c, v4
    s_waitcnt lgkmcnt(0)
    v_perm_b32 v108, v108, v108, v4
    v_perm_b32 v109, v109, v109, v4
    v_perm_b32 v110, v110, v110, v4
    v_perm_b32 v111, v111, v111, v4
    v_perm_b32 v112, v112, v112, v4
    v_perm_b32 v113, v113, v113, v4
    v_perm_b32 v114, v114, v114, v4
    v_perm_b32 v115, v115, v115, v4
    v_fma_f32 v108, v108, s67, -v116
    v_fma_f32 v109, v109, s67, -v116
    v_fma_f32 v110, v110, s67, -v116
    v_fma_f32 v111, v111, s67, -v116
    v_fma_f32 v112, v112, s67, -v116
    v_fma_f32 v113, v113, s67, -v116
    v_fma_f32 v114, v114, s67, -v116
    v_fma_f32 v115, v115, s67, -v116
    v_exp_f32 v108, v108
    v_exp_f32 v109, v109
    v_exp_f32 v110, v110
    v_exp_f32 v111, v111
    v_exp_f32 v112, v112
    v_exp_f32 v113, v113
    v_exp_f32 v114, v114
    v_exp_f32 v115, v115
    v_mul_f32 v108, v108, v117
    v_mul_f32 v109, v109, v117
    v_mul_f32 v110, v110, v117
    v_mul_f32 v111, v111, v117
    v_mul_f32 v112, v112, v117
    v_mul_f32 v113, v113, v117
    v_mul_f32 v114, v114, v117
    v_mul_f32 v115, v115, v117
    v_cvt_pk_bf16_f32 v96, v108, v112
    v_cvt_pk_bf16_f32 v97, v109, v113
    v_cvt_pk_bf16_f32 v98, v110, v114
    v_cvt_pk_bf16_f32 v99, v111, v115
    s_add_u32 m0, s101, 2048
    s_waitcnt vmcnt(2)
    buffer_load_dwordx4 v14, s[12:15], s74 offen offset:2048 nt lds
    v_mov_b32_dpp v16, v96 quad_perm:[0,1,2,3] row_mask:0xf bank_mask:0x1
    v_mov_b32_dpp v17, v97 quad_perm:[0,1,2,3] row_mask:0xf bank_mask:0x1
    v_mov_b32_dpp v18, v98 quad_perm:[0,1,2,3] row_mask:0xf bank_mask:0x1
    v_mov_b32_dpp v19, v99 quad_perm:[0,1,2,3] row_mask:0xf bank_mask:0x1
    v_mov_b32_dpp v20, v96 row_ror:4 row_mask:0xf bank_mask:0x2
    v_mov_b32_dpp v21, v97 row_ror:4 row_mask:0xf bank_mask:0x2
    v_mov_b32_dpp v22, v98 row_ror:4 row_mask:0xf bank_mask:0x2
    v_mov_b32_dpp v23, v99 row_ror:4 row_mask:0xf bank_mask:0x2
    v_mov_b32_dpp v24, v96 row_ror:8 row_mask:0xf bank_mask:0x4
    v_mov_b32_dpp v25, v97 row_ror:8 row_mask:0xf bank_mask:0x4
    v_mov_b32_dpp v26, v98 row_ror:8 row_mask:0xf bank_mask:0x4
    v_mov_b32_dpp v27, v99 row_ror:8 row_mask:0xf bank_mask:0x4
    v_mov_b32_dpp v28, v96 row_ror:12 row_mask:0xf bank_mask:0x8
    v_mov_b32_dpp v29, v97 row_ror:12 row_mask:0xf bank_mask:0x8
    v_mov_b32_dpp v30, v98 row_ror:12 row_mask:0xf bank_mask:0x8
    v_mov_b32_dpp v31, v99 row_ror:12 row_mask:0xf bank_mask:0x8
    s_waitcnt vmcnt(13)
    v_perm_b32 v108, v68, v64, s64
    v_perm_b32 v109, v76, v72, s64
    v_perm_b32 v110, v84, v80, s64
    v_perm_b32 v111, v92, v88, s64
    s_nop 1
    v_mfma_f32_16x16x32_bf16 v[100:103], v[16:19], v[108:111], 0
    v_perm_b32 v112, v68, v64, s65
    v_perm_b32 v113, v76, v72, s65
    v_perm_b32 v114, v84, v80, s65
    v_perm_b32 v115, v92, v88, s65
    s_nop 1
    v_mfma_f32_16x16x32_bf16 v[100:103], v[20:23], v[112:115], v[100:103]
    v_perm_b32 v116, v69, v65, s64
    v_perm_b32 v117, v77, v73, s64
    v_perm_b32 v118, v85, v81, s64
    v_perm_b32 v119, v93, v89, s64
    s_nop 1
    v_mfma_f32_16x16x32_bf16 v[100:103], v[24:27], v[116:119], v[100:103]
    s_add_u32 m0, s101, 2560
    s_waitcnt vmcnt(2)
    buffer_load_dwordx4 v14, s[12:15], s74 offen offset:2560 nt lds
    v_perm_b32 v120, v69, v65, s65
    v_perm_b32 v121, v77, v73, s65
    v_perm_b32 v122, v85, v81, s65
    v_perm_b32 v123, v93, v89, s65
    s_nop 1
    v_mfma_f32_16x16x32_bf16 v[100:103], v[28:31], v[120:123], v[100:103]
    v_perm_b32 v108, v70, v66, s64
    v_perm_b32 v109, v78, v74, s64
    v_perm_b32 v110, v86, v82, s64
    v_perm_b32 v111, v94, v90, s64
    s_nop 1
    v_mfma_f32_16x16x32_bf16 v[104:107], v[16:19], v[108:111], 0
    v_perm_b32 v112, v70, v66, s65
    v_perm_b32 v113, v78, v74, s65
    v_perm_b32 v114, v86, v82, s65
    v_perm_b32 v115, v94, v90, s65
    s_nop 1
    v_mfma_f32_16x16x32_bf16 v[104:107], v[20:23], v[112:115], v[104:107]
    v_perm_b32 v116, v71, v67, s64
    v_perm_b32 v117, v79, v75, s64
    v_perm_b32 v118, v87, v83, s64
    v_perm_b32 v119, v95, v91, s64
    s_nop 1
    v_mfma_f32_16x16x32_bf16 v[104:107], v[24:27], v[116:119], v[104:107]
    v_perm_b32 v120, v71, v67, s65
    v_perm_b32 v121, v79, v75, s65
    v_perm_b32 v122, v87, v83, s65
    v_perm_b32 v123, v95, v91, s65
    s_nop 1
    v_mfma_f32_16x16x32_bf16 v[104:107], v[28:31], v[120:123], v[104:107]
    s_add_u32 m0, s101, 3072
    s_waitcnt vmcnt(2)
    buffer_load_dwordx4 v14, s[12:15], s74 offen offset:3072 nt lds
    s_add_u32 m0, s101, 3584
    s_waitcnt vmcnt(2)
    buffer_load_dwordx4 v14, s[12:15], s74 offen offset:3584 nt lds
    s_waitcnt vmcnt(2)
    buffer_load_dwordx4 v[64:67], v14, s[12:15], s75 offen offset:0 nt
    v_mov_b32_dpp v16, v96 row_ror:12 row_mask:0xf bank_mask:0x1
    v_mov_b32_dpp v17, v97 row_ror:12 row_mask:0xf bank_mask:0x1
    v_mov_b32_dpp v18, v98 row_ror:12 row_mask:0xf bank_mask:0x1
    v_mov_b32_dpp v19, v99 row_ror:12 row_mask:0xf bank_mask:0x1
    v_mov_b32_dpp v20, v96 quad_perm:[0,1,2,3] row_mask:0xf bank_mask:0x2
    v_mov_b32_dpp v21, v97 quad_perm:[0,1,2,3] row_mask:0xf bank_mask:0x2
    v_mov_b32_dpp v22, v98 quad_perm:[0,1,2,3] row_mask:0xf bank_mask:0x2
    v_mov_b32_dpp v23, v99 quad_perm:[0,1,2,3] row_mask:0xf bank_mask:0x2
    v_mov_b32_dpp v24, v96 row_ror:4 row_mask:0xf bank_mask:0x4
    v_mov_b32_dpp v25, v97 row_ror:4 row_mask:0xf bank_mask:0x4
    v_mov_b32_dpp v26, v98 row_ror:4 row_mask:0xf bank_mask:0x4
    v_mov_b32_dpp v27, v99 row_ror:4 row_mask:0xf bank_mask:0x4
    v_mov_b32_dpp v28, v96 row_ror:8 row_mask:0xf bank_mask:0x8
    v_mov_b32_dpp v29, v97 row_ror:8 row_mask:0xf bank_mask:0x8
    v_mov_b32_dpp v30, v98 row_ror:8 row_mask:0xf bank_mask:0x8
    v_mov_b32_dpp v31, v99 row_ror:8 row_mask:0xf bank_mask:0x8
    s_waitcnt vmcnt(9)
    v_perm_b32 v108, v36, v32, s64
    v_perm_b32 v109, v44, v40, s64
    v_perm_b32 v110, v52, v48, s64
    v_perm_b32 v111, v60, v56, s64
    s_nop 1
    v_mfma_f32_16x16x32_bf16 v[100:103], v[16:19], v[108:111], v[100:103]
    v_perm_b32 v112, v36, v32, s65
    v_perm_b32 v113, v44, v40, s65
    v_perm_b32 v114, v52, v48, s65
    v_perm_b32 v115, v60, v56, s65
    s_nop 1
    v_mfma_f32_16x16x32_bf16 v[100:103], v[20:23], v[112:115], v[100:103]
    v_perm_b32 v116, v37, v33, s64
    v_perm_b32 v117, v45, v41, s64
    v_perm_b32 v118, v53, v49, s64
    v_perm_b32 v119, v61, v57, s64
    s_nop 1
    v_mfma_f32_16x16x32_bf16 v[100:103], v[24:27], v[116:119], v[100:103]
    v_perm_b32 v120, v37, v33, s65
    v_perm_b32 v121, v45, v41, s65
    v_perm_b32 v122, v53, v49, s65
    v_perm_b32 v123, v61, v57, s65
    s_nop 1
    v_mfma_f32_16x16x32_bf16 v[100:103], v[28:31], v[120:123], v[100:103]
    s_waitcnt vmcnt(2)
    buffer_load_dwordx4 v[68:71], v14, s[12:15], s75 offen offset:512 nt
    v_perm_b32 v108, v38, v34, s64
    v_perm_b32 v109, v46, v42, s64
    v_perm_b32 v110, v54, v50, s64
    v_perm_b32 v111, v62, v58, s64
    s_nop 1
    v_mfma_f32_16x16x32_bf16 v[104:107], v[16:19], v[108:111], v[104:107]
    v_perm_b32 v112, v38, v34, s65
    v_perm_b32 v113, v46, v42, s65
    v_perm_b32 v114, v54, v50, s65
    v_perm_b32 v115, v62, v58, s65
    s_nop 1
    v_mfma_f32_16x16x32_bf16 v[104:107], v[20:23], v[112:115], v[104:107]
    v_perm_b32 v116, v39, v35, s64
    v_perm_b32 v117, v47, v43, s64
    v_perm_b32 v118, v55, v51, s64
    v_perm_b32 v119, v63, v59, s64
    s_nop 1
    v_mfma_f32_16x16x32_bf16 v[104:107], v[24:27], v[116:119], v[104:107]
    v_perm_b32 v120, v39, v35, s65
    v_perm_b32 v121, v47, v43, s65
    v_perm_b32 v122, v55, v51, s65
    v_perm_b32 v123, v63, v59, s65
    s_nop 1
    v_mfma_f32_16x16x32_bf16 v[104:107], v[28:31], v[120:123], v[104:107]
    s_waitcnt vmcnt(2)
    buffer_load_dwordx4 v[72:75], v14, s[12:15], s75 offen offset:1024 nt
    s_waitcnt vmcnt(2)
    buffer_load_dwordx4 v[76:79], v14, s[12:15], s75 offen offset:1536 nt
    s_waitcnt vmcnt(4)
    ds_read_b128 v[32:35], v15 offset:0
    ds_read_b128 v[36:39], v15 offset:1024
    ds_read_b128 v[40:43], v15 offset:2048
    ds_read_b128 v[44:47], v15 offset:3072
    ds_read_b128 v[48:51], v15 offset:4096
    ds_read_b128 v[52:55], v15 offset:5120
    ds_read_b128 v[56:59], v15 offset:6144
    ds_read_b128 v[60:63], v15 offset:7168
    v_mov_b32_dpp v16, v96 row_ror:8 row_mask:0xf bank_mask:0x1
    v_mov_b32_dpp v17, v97 row_ror:8 row_mask:0xf bank_mask:0x1
    v_mov_b32_dpp v18, v98 row_ror:8 row_mask:0xf bank_mask:0x1
    v_mov_b32_dpp v19, v99 row_ror:8 row_mask:0xf bank_mask:0x1
    v_mov_b32_dpp v20, v96 row_ror:12 row_mask:0xf bank_mask:0x2
    v_mov_b32_dpp v21, v97 row_ror:12 row_mask:0xf bank_mask:0x2
    v_mov_b32_dpp v22, v98 row_ror:12 row_mask:0xf bank_mask:0x2
    v_mov_b32_dpp v23, v99 row_ror:12 row_mask:0xf bank_mask:0x2
    v_mov_b32_dpp v24, v96 quad_perm:[0,1,2,3] row_mask:0xf bank_mask:0x4
    v_mov_b32_dpp v25, v97 quad_perm:[0,1,2,3] row_mask:0xf bank_mask:0x4
    v_mov_b32_dpp v26, v98 quad_perm:[0,1,2,3] row_mask:0xf bank_mask:0x4
    v_mov_b32_dpp v27, v99 quad_perm:[0,1,2,3] row_mask:0xf bank_mask:0x4
    v_mov_b32_dpp v28, v96 row_ror:4 row_mask:0xf bank_mask:0x8
    v_mov_b32_dpp v29, v97 row_ror:4 row_mask:0xf bank_mask:0x8
    v_mov_b32_dpp v30, v98 row_ror:4 row_mask:0xf bank_mask:0x8
    v_mov_b32_dpp v31, v99 row_ror:4 row_mask:0xf bank_mask:0x8
    s_waitcnt lgkmcnt(0)
    s_waitcnt vmcnt(2)
    buffer_load_dwordx4 v[80:83], v14, s[12:15], s75 offen offset:2048 nt
    v_perm_b32 v108, v36, v32, s64
    v_perm_b32 v109, v44, v40, s64
    v_perm_b32 v110, v52, v48, s64
    v_perm_b32 v111, v60, v56, s64
    s_nop 1
    v_mfma_f32_16x16x32_bf16 v[100:103], v[16:19], v[108:111], v[100:103]
    v_perm_b32 v112, v36, v32, s65
    v_perm_b32 v113, v44, v40, s65
    v_perm_b32 v114, v52, v48, s65
    v_perm_b32 v115, v60, v56, s65
    s_nop 1
    v_mfma_f32_16x16x32_bf16 v[100:103], v[20:23], v[112:115], v[100:103]
    v_perm_b32 v116, v37, v33, s64
    v_perm_b32 v117, v45, v41, s64
    v_perm_b32 v118, v53, v49, s64
    v_perm_b32 v119, v61, v57, s64
    s_nop 1
    v_mfma_f32_16x16x32_bf16 v[100:103], v[24:27], v[116:119], v[100:103]
    v_perm_b32 v120, v37, v33, s65
    v_perm_b32 v121, v45, v41, s65
    v_perm_b32 v122, v53, v49, s65
    v_perm_b32 v123, v61, v57, s65
    s_nop 1
    v_mfma_f32_16x16x32_bf16 v[100:103], v[28:31], v[120:123], v[100:103]
    s_waitcnt vmcnt(2)
    buffer_load_dwordx4 v[84:87], v14, s[12:15], s75 offen offset:2560 nt
    v_perm_b32 v108, v38, v34, s64
    v_perm_b32 v109, v46, v42, s64
    v_perm_b32 v110, v54, v50, s64
    v_perm_b32 v111, v62, v58, s64
    s_nop 1
    v_mfma_f32_16x16x32_bf16 v[104:107], v[16:19], v[108:111], v[104:107]
    v_perm_b32 v112, v38, v34, s65
    v_perm_b32 v113, v46, v42, s65
    v_perm_b32 v114, v54, v50, s65
    v_perm_b32 v115, v62, v58, s65
    s_nop 1
    v_mfma_f32_16x16x32_bf16 v[104:107], v[20:23], v[112:115], v[104:107]
    v_perm_b32 v116, v39, v35, s64
    v_perm_b32 v117, v47, v43, s64
    v_perm_b32 v118, v55, v51, s64
    v_perm_b32 v119, v63, v59, s64
    s_nop 1
    v_mfma_f32_16x16x32_bf16 v[104:107], v[24:27], v[116:119], v[104:107]
    v_perm_b32 v120, v39, v35, s65
    v_perm_b32 v121, v47, v43, s65
    v_perm_b32 v122, v55, v51, s65
    v_perm_b32 v123, v63, v59, s65
    s_nop 1
    v_mfma_f32_16x16x32_bf16 v[104:107], v[28:31], v[120:123], v[104:107]
    s_waitcnt vmcnt(2)
    buffer_load_dwordx4 v[88:91], v14, s[12:15], s75 offen offset:3072 nt
    s_waitcnt vmcnt(2)
    buffer_load_dwordx4 v[92:95], v14, s[12:15], s75 offen offset:3584 nt
    v_mov_b32 v3, 1
    s_mov_b64 exec, 1
    ds_add_u32 v2, v3 offset:68
    s_mov_b64 exec, -1
    s_branch L_vlast
L_v3:
    s_waitcnt vmcnt(4)
    buffer_load_dwordx4 v[64:67], v14, s[12:15], s72 offen offset:0 nt
    s_waitcnt vmcnt(29)
    v_mfma_f32_16x16x32_bf16 v[4:7], v[16:19], v[32:35], 0
    v_mfma_f32_16x16x32_bf16 v[4:7], v[20:23], v[36:39], v[4:7]
    v_mfma_f32_16x16x32_bf16 v[4:7], v[24:27], v[40:43], v[4:7]
    v_mfma_f32_16x16x32_bf16 v[4:7], v[28:31], v[44:47], v[4:7]
    v_add_f32_dpp v1, v8, v10 quad_perm:[0,0,2,2] row_mask:0x2 bank_mask:0xf
    v_add_f32_dpp v15, v9, v11 quad_perm:[0,0,2,2] row_mask:0x2 bank_mask:0xf
    s_waitcnt vmcnt(25)
    v_mfma_f32_16x16x32_bf16 v[8:11], v[16:19], v[48:51], 0
    v_mfma_f32_16x16x32_bf16 v[8:11], v[20:23], v[52:55], v[8:11]
    v_mfma_f32_16x16x32_bf16 v[8:11], v[24:27], v[56:59], v[8:11]
    v_mfma_f32_16x16x32_bf16 v[8:11], v[28:31], v[60:63], v[8:11]
    s_nop 0
    v_add_f32_dpp v12, v6, v4 quad_perm:[1,1,3,3] row_mask:0x1 bank_mask:0xf
    v_add_f32_dpp v13, v7, v5 quad_perm:[1,1,3,3] row_mask:0x1 bank_mask:0xf
    s_mov_b32 s101, s33
    s_waitcnt vmcnt(4)
    buffer_load_dwordx4 v[68:71], v14, s[12:15], s72 offen offset:512 nt
    s_waitcnt vmcnt(14)
    v_mfma_f32_16x16x32_bf16 v[4:7], v[16:19], v[96:99], 0
    v_mfma_f32_16x16x32_bf16 v[4:7], v[20:23], v[100:103], v[4:7]
    v_mfma_f32_16x16x32_bf16 v[4:7], v[24:27], v[104:107], v[4:7]
    v_mfma_f32_16x16x32_bf16 v[4:7], v[28:31], v[108:111], v[4:7]
    v_add_f32_dpp v1, v8, v10 quad_perm:[0,0,2,2] row_mask:0x1 bank_mask:0xf
    v_add_f32_dpp v15, v9, v11 quad_perm:[0,0,2,2] row_mask:0x1 bank_mask:0xf
    s_waitcnt vmcnt(10)
    v_mfma_f32_16x16x32_bf16 v[8:11], v[16:19], v[112:115], 0
    v_mfma_f32_16x16x32_bf16 v[8:11], v[20:23], v[116:119], v[8:11]
    v_mfma_f32_16x16x32_bf16 v[8:11], v[24:27], v[120:123], v[8:11]
    v_mfma_f32_16x16x32_bf16 v[8:11], v[28:31], v[124:127], v[8:11]
    s_nop 0
    v_add_f32_dpp v12, v6, v4 quad_perm:[1,1,3,3] row_mask:0x4 bank_mask:0xf
    v_add_f32_dpp v13, v7, v5 quad_perm:[1,1,3,3] row_mask:0x4 bank_mask:0xf
    s_waitcnt vmcnt(4)
    buffer_load_dwordx4 v[72:75], v14, s[12:15], s72 offen offset:1024 nt
    s_nop 2
    v_add_f32_dpp v1, v8, v10 quad_perm:[0,0,2,2] row_mask:0x4 bank_mask:0xf
    v_add_f32_dpp v15, v9, v11 quad_perm:[0,0,2,2] row_mask:0x4 bank_mask:0xf
    v_lshlrev_b32 v3, 4, v0
    v_add_u32 v3, s33, v3
    s_waitcnt vmcnt(3)
    ds_read_b128 v[96:99], v3 offset:0
    ds_read_b128 v[100:103], v3 offset:1024
    ds_read_b128 v[104:107], v3 offset:2048
    ds_read_b128 v[108:111], v3 offset:3072
    ds_read_b128 v[112:115], v3 offset:4096
    ds_read_b128 v[116:119], v3 offset:5120
    ds_read_b128 v[120:123], v3 offset:6144
    ds_read_b128 v[124:127], v3 offset:7168
    s_waitcnt lgkmcnt(4)
    v_mfma_f32_16x16x32_bf16 v[4:7], v[16:19], v[96:99], 0
    v_mfma_f32_16x16x32_bf16 v[4:7], v[20:23], v[100:103], v[4:7]
    v_mfma_f32_16x16x32_bf16 v[4:7], v[24:27], v[104:107], v[4:7]
    v_mfma_f32_16x16x32_bf16 v[4:7], v[28:31], v[108:111], v[4:7]
    s_waitcnt lgkmcnt(0)
    v_mfma_f32_16x16x32_bf16 v[8:11], v[16:19], v[112:115], 0
    v_mfma_f32_16x16x32_bf16 v[8:11], v[20:23], v[116:119], v[8:11]
    v_mfma_f32_16x16x32_bf16 v[8:11], v[24:27], v[120:123], v[8:11]
    v_mfma_f32_16x16x32_bf16 v[8:11], v[28:31], v[124:127], v[8:11]
    s_nop 2
    v_add_f32_dpp v12, v6, v4 quad_perm:[1,1,3,3] row_mask:0x8 bank_mask:0xf
    v_add_f32_dpp v13, v7, v5 quad_perm:[1,1,3,3] row_mask:0x8 bank_mask:0xf
    s_nop 2
    v_add_f32_dpp v1, v8, v10 quad_perm:[0,0,2,2] row_mask:0x8 bank_mask:0xf
    v_add_f32_dpp v15, v9, v11 quad_perm:[0,0,2,2] row_mask:0x8 bank_mask:0xf
    s_waitcnt vmcnt(4)
    buffer_load_dwordx4 v[76:79], v14, s[12:15], s72 offen offset:1536 nt
    s_mov_b32 s30, 0xaaaaaaaa
    s_mov_b32 s31, 0xaaaaaaaa
    v_cndmask_b32 v12, v12, v1, s[30:31]
    v_cndmask_b32 v13, v13, v15, s[30:31]
    v_lshlrev_b32 v15, 4, v0
    v_add_u32 v15, s101, v15
    v_cvt_pk_bf16_f32 v96, v12, v13
    s_lshl_b32 s30, s5, 3
    s_add_u32 s30, s30, s4
    s_lshl_b32 s31, s6, 3
    s_add_u32 s31, s31, s3
    v_min_u32 v96, -2, v96
    s_lshl_b32 s32, s30, 13
    s_lshl_b32 s33, s31, 8
    s_add_u32 s32, s32, s33
    s_add_u32 s32, s32, 131072
    v_and_b32 v3, 0x30, v0
    v_and_b32 v97, 1, v0
    v_lshl_add_u32 v3, v97, 3, v3
    v_bfe_u32 v97, v0, 1, 3
    v_add_lshl_u32 v3, v3, v97, 2
    buffer_store_dword v96, v3, s[24:27], s32 offen sc1
    v_lshlrev_b32 v12, 16, v96
    v_and_b32 v13, s66, v96
    v_mov_b32 v100, v12
    v_mov_b32 v101, v13
    s_nop 1
    v_permlane32_swap_b32 v100, v101
    v_max_f32 v100, v100, v101
    s_nop 1
    v_max_f32_dpp v100, v100, v100 row_ror:1 row_mask:0xf bank_mask:0xf
    s_nop 1
    v_max_f32_dpp v100, v100, v100 row_ror:2 row_mask:0xf bank_mask:0xf
    s_nop 1
    v_max_f32_dpp v100, v100, v100 row_ror:4 row_mask:0xf bank_mask:0xf
    s_nop 1
    v_max_f32_dpp v100, v100, v100 row_ror:8 row_mask:0xf bank_mask:0xf
    v_mov_b32 v3, v100
    s_nop 1
    v_permlane16_swap_b32 v3, v100
    v_max_f32 v100, v100, v3
    v_mov_b32 v102, v100
    s_nop 1
    v_permlane32_swap_b32 v100, v102
    s_lshl_b32 s32, s30, 9
    s_lshl_b32 s33, s31, 4
    s_add_u32 s32, s32, s33
    s_add_u32 s32, s32, 655360
    v_sub_f32 v101, v12, v100
    v_sub_f32 v103, v13, v102
    v_mul_f32 v101, s67, v101
    v_mul_f32 v103, s67, v103
    v_exp_f32 v101, v101
    v_exp_f32 v103, v103
    s_nop 1
    v_permlane32_swap_b32 v101, v103
    v_add_f32 v101, v101, v103
    s_nop 1
    v_add_f32_dpp v101, v101, v101 row_ror:1 row_mask:0xf bank_mask:0xf
    s_nop 1
    v_add_f32_dpp v101, v101, v101 row_ror:2 row_mask:0xf bank_mask:0xf
    s_nop 1
    v_add_f32_dpp v101, v101, v101 row_ror:4 row_mask:0xf bank_mask:0xf
    s_nop 1
    v_add_f32_dpp v101, v101, v101 row_ror:8 row_mask:0xf bank_mask:0xf
    v_mov_b32 v3, v101
    s_nop 1
    v_permlane16_swap_b32 v3, v101
    v_add_f32 v101, v101, v3
    v_mov_b32 v103, v101
    s_nop 1
    v_permlane32_swap_b32 v101, v103
    s_mov_b64 exec, 1
    buffer_store_dwordx4 v[100:103], v2, s[24:27], s32 offen sc1
    v_mov_b32 v3, 1
    ds_add_u32 v2, v3 offset:12
    s_mov_b64 exec, -1
    s_waitcnt vmcnt(4)
    buffer_load_dwordx4 v[80:83], v14, s[12:15], s72 offen offset:2048 nt
    s_waitcnt vmcnt(4)
    buffer_load_dwordx4 v[84:87], v14, s[12:15], s72 offen offset:2560 nt
    v_mov_b32 v16, 0
    v_mov_b32 v17, 0
    v_mov_b32 v18, 0
    v_mov_b32 v19, 0
    v_mov_b32 v20, 0
    v_mov_b32 v21, 0
    v_mov_b32 v22, 0
    v_mov_b32 v23, 0
    v_mov_b32 v24, 0
    v_mov_b32 v25, 0
    v_mov_b32 v26, 0
    v_mov_b32 v27, 0
    v_mov_b32 v28, 0
    v_mov_b32 v29, 0
    v_mov_b32 v30, 0
    v_mov_b32 v31, 0
    s_waitcnt vmcnt(4)
    buffer_load_dwordx4 v[88:91], v14, s[12:15], s72 offen offset:3072 nt
    s_waitcnt vmcnt(4)
    buffer_load_dwordx4 v[92:95], v14, s[12:15], s72 offen offset:3584 nt
    s_waitcnt vmcnt(4)
    buffer_load_dwordx4 v[32:35], v14, s[12:15], s73 offen offset:0 nt
    s_waitcnt vmcnt(4)
    buffer_load_dwordx4 v[36:39], v14, s[12:15], s73 offen offset:512 nt
    s_waitcnt vmcnt(4)
    buffer_load_dwordx4 v[40:43], v14, s[12:15], s73 offen offset:1024 nt
    v_mov_b32 v3, 1
    s_mov_b64 exec, 1
    ds_add_u32 v2, v3 offset:64
    s_mov_b64 exec, -1
    s_waitcnt vmcnt(4)
    buffer_load_dwordx4 v[44:47], v14, s[12:15], s73 offen offset:1536 nt
    s_waitcnt vmcnt(4)
    buffer_load_dwordx4 v[48:51], v14, s[12:15], s73 offen offset:2048 nt
    s_waitcnt vmcnt(4)
    buffer_load_dwordx4 v[52:55], v14, s[12:15], s73 offen offset:2560 nt
    s_waitcnt vmcnt(4)
    buffer_load_dwordx4 v[56:59], v14, s[12:15], s73 offen offset:3072 nt
    s_waitcnt vmcnt(4)
    buffer_load_dwordx4 v[60:63], v14, s[12:15], s73 offen offset:3584 nt
    s_add_u32 m0, s101, 0
    s_waitcnt vmcnt(4)
    buffer_load_dwordx4 v14, s[12:15], s74 offen offset:0 nt lds
    s_add_u32 m0, s101, 512
    s_waitcnt vmcnt(4)
    buffer_load_dwordx4 v14, s[12:15], s74 offen offset:512 nt lds
    s_add_u32 m0, s101, 1024
    s_waitcnt vmcnt(4)
    buffer_load_dwordx4 v14, s[12:15], s74 offen offset:1024 nt lds
    s_add_u32 m0, s101, 1536
    s_waitcnt vmcnt(4)
    buffer_load_dwordx4 v14, s[12:15], s74 offen offset:1536 nt lds
spin_11:
    ds_read_b32 v3, v2 offset:4
    s_waitcnt lgkmcnt(0)
    v_readfirstlane_b32 s30, v3
    s_nop 0
    s_cmp_ge_u32 s30, 1
    s_cbranch_scc1 spind_12
    s_sleep 1
    s_branch spin_11
spind_12:
    v_lshrrev_b32 v3, 4, v0
    v_bfe_u32 v4, v0, 1, 1
    v_lshlrev_b32 v3, 9, v3
    v_lshl_add_u32 v3, v4, 4, v3
    v_bfe_u32 v4, v0, 2, 2
    v_lshl_add_u32 v3, v4, 6, v3
    s_and_b32 s30, s3, 3
    s_lshl_b32 s30, s30, 11
    s_lshr_b32 s31, s3, 2
    s_lshl_b32 s31, s31, 5
    s_add_u32 s30, s30, s31
    v_add_u32 v3, s30, v3
    ds_read_b128 v[108:111], v3 offset:10240
    ds_read_b128 v[112:115], v3 offset:10496
    v_and_b32 v4, 1, v0
    v_lshlrev_b32 v5, 3, v4
    ds_read_b64 v[116:117], v5 offset:32
    v_mul_u32_u24 v4, 0x0202, v4
    v_lshlrev_b32 v4, 16, v4
    v_add_u32 v4, 0x05040c0c, v4
    s_waitcnt lgkmcnt(0)
    v_perm_b32 v108, v108, v108, v4
    v_perm_b32 v109, v109, v109, v4
    v_perm_b32 v110, v110, v110, v4
    v_perm_b32 v111, v111, v111, v4
    v_perm_b32 v112, v112, v112, v4
    v_perm_b32 v113, v113, v113, v4
    v_perm_b32 v114, v114, v114, v4
    v_perm_b32 v115, v115, v115, v4
    v_fma_f32 v108, v108, s67, -v116
    v_fma_f32 v109, v109, s67, -v116
    v_fma_f32 v110, v110, s67, -v116
    v_fma_f32 v111, v111, s67, -v116
    v_fma_f32 v112, v112, s67, -v116
    v_fma_f32 v113, v113, s67, -v116
    v_fma_f32 v114, v114, s67, -v116
    v_fma_f32 v115, v115, s67, -v116
    v_exp_f32 v108, v108
    v_exp_f32 v109, v109
    v_exp_f32 v110, v110
    v_exp_f32 v111, v111
    v_exp_f32 v112, v112
    v_exp_f32 v113, v113
    v_exp_f32 v114, v114
    v_exp_f32 v115, v115
    v_mul_f32 v108, v108, v117
    v_mul_f32 v109, v109, v117
    v_mul_f32 v110, v110, v117
    v_mul_f32 v111, v111, v117
    v_mul_f32 v112, v112, v117
    v_mul_f32 v113, v113, v117
    v_mul_f32 v114, v114, v117
    v_mul_f32 v115, v115, v117
    v_cvt_pk_bf16_f32 v96, v108, v112
    v_cvt_pk_bf16_f32 v97, v109, v113
    v_cvt_pk_bf16_f32 v98, v110, v114
    v_cvt_pk_bf16_f32 v99, v111, v115
    s_add_u32 m0, s101, 2048
    s_waitcnt vmcnt(3)
    buffer_load_dwordx4 v14, s[12:15], s74 offen offset:2048 nt lds
    v_mov_b32_dpp v16, v96 quad_perm:[0,1,2,3] row_mask:0xf bank_mask:0x1
    v_mov_b32_dpp v17, v97 quad_perm:[0,1,2,3] row_mask:0xf bank_mask:0x1
    v_mov_b32_dpp v18, v98 quad_perm:[0,1,2,3] row_mask:0xf bank_mask:0x1
    v_mov_b32_dpp v19, v99 quad_perm:[0,1,2,3] row_mask:0xf bank_mask:0x1
    v_mov_b32_dpp v20, v96 row_ror:4 row_mask:0xf bank_mask:0x2
    v_mov_b32_dpp v21, v97 row_ror:4 row_mask:0xf bank_mask:0x2
    v_mov_b32_dpp v22, v98 row_ror:4 row_mask:0xf bank_mask:0x2
    v_mov_b32_dpp v23, v99 row_ror:4 row_mask:0xf bank_mask:0x2
    v_mov_b32_dpp v24, v96 row_ror:8 row_mask:0xf bank_mask:0x4
    v_mov_b32_dpp v25, v97 row_ror:8 row_mask:0xf bank_mask:0x4
    v_mov_b32_dpp v26, v98 row_ror:8 row_mask:0xf bank_mask:0x4
    v_mov_b32_dpp v27, v99 row_ror:8 row_mask:0xf bank_mask:0x4
    v_mov_b32_dpp v28, v96 row_ror:12 row_mask:0xf bank_mask:0x8
    v_mov_b32_dpp v29, v97 row_ror:12 row_mask:0xf bank_mask:0x8
    v_mov_b32_dpp v30, v98 row_ror:12 row_mask:0xf bank_mask:0x8
    v_mov_b32_dpp v31, v99 row_ror:12 row_mask:0xf bank_mask:0x8
    s_waitcnt vmcnt(13)
    v_perm_b32 v108, v68, v64, s64
    v_perm_b32 v109, v76, v72, s64
    v_perm_b32 v110, v84, v80, s64
    v_perm_b32 v111, v92, v88, s64
    s_nop 1
    v_mfma_f32_16x16x32_bf16 v[100:103], v[16:19], v[108:111], 0
    v_perm_b32 v112, v68, v64, s65
    v_perm_b32 v113, v76, v72, s65
    v_perm_b32 v114, v84, v80, s65
    v_perm_b32 v115, v92, v88, s65
    s_nop 1
    v_mfma_f32_16x16x32_bf16 v[100:103], v[20:23], v[112:115], v[100:103]
    v_perm_b32 v116, v69, v65, s64
    v_perm_b32 v117, v77, v73, s64
    v_perm_b32 v118, v85, v81, s64
    v_perm_b32 v119, v93, v89, s64
    s_nop 1
    v_mfma_f32_16x16x32_bf16 v[100:103], v[24:27], v[116:119], v[100:103]
    s_add_u32 m0, s101, 2560
    s_waitcnt vmcnt(3)
    buffer_load_dwordx4 v14, s[12:15], s74 offen offset:2560 nt lds
    v_perm_b32 v120, v69, v65, s65
    v_perm_b32 v121, v77, v73, s65
    v_perm_b32 v122, v85, v81, s65
    v_perm_b32 v123, v93, v89, s65
    s_nop 1
    v_mfma_f32_16x16x32_bf16 v[100:103], v[28:31], v[120:123], v[100:103]
    v_perm_b32 v108, v70, v66, s64
    v_perm_b32 v109, v78, v74, s64
    v_perm_b32 v110, v86, v82, s64
    v_perm_b32 v111, v94, v90, s64
    s_nop 1
    v_mfma_f32_16x16x32_bf16 v[104:107], v[16:19], v[108:111], 0
    v_perm_b32 v112, v70, v66, s65
    v_perm_b32 v113, v78, v74, s65
    v_perm_b32 v114, v86, v82, s65
    v_perm_b32 v115, v94, v90, s65
    s_nop 1
    v_mfma_f32_16x16x32_bf16 v[104:107], v[20:23], v[112:115], v[104:107]
    v_perm_b32 v116, v71, v67, s64
    v_perm_b32 v117, v79, v75, s64
    v_perm_b32 v118, v87, v83, s64
    v_perm_b32 v119, v95, v91, s64
    s_nop 1
    v_mfma_f32_16x16x32_bf16 v[104:107], v[24:27], v[116:119], v[104:107]
    v_perm_b32 v120, v71, v67, s65
    v_perm_b32 v121, v79, v75, s65
    v_perm_b32 v122, v87, v83, s65
    v_perm_b32 v123, v95, v91, s65
    s_nop 1
    v_mfma_f32_16x16x32_bf16 v[104:107], v[28:31], v[120:123], v[104:107]
    s_add_u32 m0, s101, 3072
    s_waitcnt vmcnt(3)
    buffer_load_dwordx4 v14, s[12:15], s74 offen offset:3072 nt lds
    s_add_u32 m0, s101, 3584
    s_waitcnt vmcnt(3)
    buffer_load_dwordx4 v14, s[12:15], s74 offen offset:3584 nt lds
    s_waitcnt vmcnt(3)
    buffer_load_dwordx4 v[64:67], v14, s[12:15], s75 offen offset:0 nt
    v_mov_b32_dpp v16, v96 row_ror:12 row_mask:0xf bank_mask:0x1
    v_mov_b32_dpp v17, v97 row_ror:12 row_mask:0xf bank_mask:0x1
    v_mov_b32_dpp v18, v98 row_ror:12 row_mask:0xf bank_mask:0x1
    v_mov_b32_dpp v19, v99 row_ror:12 row_mask:0xf bank_mask:0x1
    v_mov_b32_dpp v20, v96 quad_perm:[0,1,2,3] row_mask:0xf bank_mask:0x2
    v_mov_b32_dpp v21, v97 quad_perm:[0,1,2,3] row_mask:0xf bank_mask:0x2
    v_mov_b32_dpp v22, v98 quad_perm:[0,1,2,3] row_mask:0xf bank_mask:0x2
    v_mov_b32_dpp v23, v99 quad_perm:[0,1,2,3] row_mask:0xf bank_mask:0x2
    v_mov_b32_dpp v24, v96 row_ror:4 row_mask:0xf bank_mask:0x4
    v_mov_b32_dpp v25, v97 row_ror:4 row_mask:0xf bank_mask:0x4
    v_mov_b32_dpp v26, v98 row_ror:4 row_mask:0xf bank_mask:0x4
    v_mov_b32_dpp v27, v99 row_ror:4 row_mask:0xf bank_mask:0x4
    v_mov_b32_dpp v28, v96 row_ror:8 row_mask:0xf bank_mask:0x8
    v_mov_b32_dpp v29, v97 row_ror:8 row_mask:0xf bank_mask:0x8
    v_mov_b32_dpp v30, v98 row_ror:8 row_mask:0xf bank_mask:0x8
    v_mov_b32_dpp v31, v99 row_ror:8 row_mask:0xf bank_mask:0x8
    s_waitcnt vmcnt(9)
    v_perm_b32 v108, v36, v32, s64
    v_perm_b32 v109, v44, v40, s64
    v_perm_b32 v110, v52, v48, s64
    v_perm_b32 v111, v60, v56, s64
    s_nop 1
    v_mfma_f32_16x16x32_bf16 v[100:103], v[16:19], v[108:111], v[100:103]
    v_perm_b32 v112, v36, v32, s65
    v_perm_b32 v113, v44, v40, s65
    v_perm_b32 v114, v52, v48, s65
    v_perm_b32 v115, v60, v56, s65
    s_nop 1
    v_mfma_f32_16x16x32_bf16 v[100:103], v[20:23], v[112:115], v[100:103]
    v_perm_b32 v116, v37, v33, s64
    v_perm_b32 v117, v45, v41, s64
    v_perm_b32 v118, v53, v49, s64
    v_perm_b32 v119, v61, v57, s64
    s_nop 1
    v_mfma_f32_16x16x32_bf16 v[100:103], v[24:27], v[116:119], v[100:103]
    v_perm_b32 v120, v37, v33, s65
    v_perm_b32 v121, v45, v41, s65
    v_perm_b32 v122, v53, v49, s65
    v_perm_b32 v123, v61, v57, s65
    s_nop 1
    v_mfma_f32_16x16x32_bf16 v[100:103], v[28:31], v[120:123], v[100:103]
    s_waitcnt vmcnt(3)
    buffer_load_dwordx4 v[68:71], v14, s[12:15], s75 offen offset:512 nt
    v_perm_b32 v108, v38, v34, s64
    v_perm_b32 v109, v46, v42, s64
    v_perm_b32 v110, v54, v50, s64
    v_perm_b32 v111, v62, v58, s64
    s_nop 1
    v_mfma_f32_16x16x32_bf16 v[104:107], v[16:19], v[108:111], v[104:107]
    v_perm_b32 v112, v38, v34, s65
    v_perm_b32 v113, v46, v42, s65
    v_perm_b32 v114, v54, v50, s65
    v_perm_b32 v115, v62, v58, s65
    s_nop 1
    v_mfma_f32_16x16x32_bf16 v[104:107], v[20:23], v[112:115], v[104:107]
    v_perm_b32 v116, v39, v35, s64
    v_perm_b32 v117, v47, v43, s64
    v_perm_b32 v118, v55, v51, s64
    v_perm_b32 v119, v63, v59, s64
    s_nop 1
    v_mfma_f32_16x16x32_bf16 v[104:107], v[24:27], v[116:119], v[104:107]
    v_perm_b32 v120, v39, v35, s65
    v_perm_b32 v121, v47, v43, s65
    v_perm_b32 v122, v55, v51, s65
    v_perm_b32 v123, v63, v59, s65
    s_nop 1
    v_mfma_f32_16x16x32_bf16 v[104:107], v[28:31], v[120:123], v[104:107]
    s_waitcnt vmcnt(3)
    buffer_load_dwordx4 v[72:75], v14, s[12:15], s75 offen offset:1024 nt
    s_waitcnt vmcnt(3)
    buffer_load_dwordx4 v[76:79], v14, s[12:15], s75 offen offset:1536 nt
    s_waitcnt vmcnt(4)
    ds_read_b128 v[32:35], v15 offset:0
    ds_read_b128 v[36:39], v15 offset:1024
    ds_read_b128 v[40:43], v15 offset:2048
    ds_read_b128 v[44:47], v15 offset:3072
    ds_read_b128 v[48:51], v15 offset:4096
    ds_read_b128 v[52:55], v15 offset:5120
    ds_read_b128 v[56:59], v15 offset:6144
    ds_read_b128 v[60:63], v15 offset:7168
    v_mov_b32_dpp v16, v96 row_ror:8 row_mask:0xf bank_mask:0x1
    v_mov_b32_dpp v17, v97 row_ror:8 row_mask:0xf bank_mask:0x1
    v_mov_b32_dpp v18, v98 row_ror:8 row_mask:0xf bank_mask:0x1
    v_mov_b32_dpp v19, v99 row_ror:8 row_mask:0xf bank_mask:0x1
    v_mov_b32_dpp v20, v96 row_ror:12 row_mask:0xf bank_mask:0x2
    v_mov_b32_dpp v21, v97 row_ror:12 row_mask:0xf bank_mask:0x2
    v_mov_b32_dpp v22, v98 row_ror:12 row_mask:0xf bank_mask:0x2
    v_mov_b32_dpp v23, v99 row_ror:12 row_mask:0xf bank_mask:0x2
    v_mov_b32_dpp v24, v96 quad_perm:[0,1,2,3] row_mask:0xf bank_mask:0x4
    v_mov_b32_dpp v25, v97 quad_perm:[0,1,2,3] row_mask:0xf bank_mask:0x4
    v_mov_b32_dpp v26, v98 quad_perm:[0,1,2,3] row_mask:0xf bank_mask:0x4
    v_mov_b32_dpp v27, v99 quad_perm:[0,1,2,3] row_mask:0xf bank_mask:0x4
    v_mov_b32_dpp v28, v96 row_ror:4 row_mask:0xf bank_mask:0x8
    v_mov_b32_dpp v29, v97 row_ror:4 row_mask:0xf bank_mask:0x8
    v_mov_b32_dpp v30, v98 row_ror:4 row_mask:0xf bank_mask:0x8
    v_mov_b32_dpp v31, v99 row_ror:4 row_mask:0xf bank_mask:0x8
    s_waitcnt lgkmcnt(0)
    s_waitcnt vmcnt(3)
    buffer_load_dwordx4 v[80:83], v14, s[12:15], s75 offen offset:2048 nt
    v_perm_b32 v108, v36, v32, s64
    v_perm_b32 v109, v44, v40, s64
    v_perm_b32 v110, v52, v48, s64
    v_perm_b32 v111, v60, v56, s64
    s_nop 1
    v_mfma_f32_16x16x32_bf16 v[100:103], v[16:19], v[108:111], v[100:103]
    v_perm_b32 v112, v36, v32, s65
    v_perm_b32 v113, v44, v40, s65
    v_perm_b32 v114, v52, v48, s65
    v_perm_b32 v115, v60, v56, s65
    s_nop 1
    v_mfma_f32_16x16x32_bf16 v[100:103], v[20:23], v[112:115], v[100:103]
    v_perm_b32 v116, v37, v33, s64
    v_perm_b32 v117, v45, v41, s64
    v_perm_b32 v118, v53, v49, s64
    v_perm_b32 v119, v61, v57, s64
    s_nop 1
    v_mfma_f32_16x16x32_bf16 v[100:103], v[24:27], v[116:119], v[100:103]
    v_perm_b32 v120, v37, v33, s65
    v_perm_b32 v121, v45, v41, s65
    v_perm_b32 v122, v53, v49, s65
    v_perm_b32 v123, v61, v57, s65
    s_nop 1
    v_mfma_f32_16x16x32_bf16 v[100:103], v[28:31], v[120:123], v[100:103]
    s_waitcnt vmcnt(3)
    buffer_load_dwordx4 v[84:87], v14, s[12:15], s75 offen offset:2560 nt
    v_perm_b32 v108, v38, v34, s64
    v_perm_b32 v109, v46, v42, s64
    v_perm_b32 v110, v54, v50, s64
    v_perm_b32 v111, v62, v58, s64
    s_nop 1
    v_mfma_f32_16x16x32_bf16 v[104:107], v[16:19], v[108:111], v[104:107]
    v_perm_b32 v112, v38, v34, s65
    v_perm_b32 v113, v46, v42, s65
    v_perm_b32 v114, v54, v50, s65
    v_perm_b32 v115, v62, v58, s65
    s_nop 1
    v_mfma_f32_16x16x32_bf16 v[104:107], v[20:23], v[112:115], v[104:107]
    v_perm_b32 v116, v39, v35, s64
    v_perm_b32 v117, v47, v43, s64
    v_perm_b32 v118, v55, v51, s64
    v_perm_b32 v119, v63, v59, s64
    s_nop 1
    v_mfma_f32_16x16x32_bf16 v[104:107], v[24:27], v[116:119], v[104:107]
    v_perm_b32 v120, v39, v35, s65
    v_perm_b32 v121, v47, v43, s65
    v_perm_b32 v122, v55, v51, s65
    v_perm_b32 v123, v63, v59, s65
    s_nop 1
    v_mfma_f32_16x16x32_bf16 v[104:107], v[28:31], v[120:123], v[104:107]
    s_waitcnt vmcnt(3)
    buffer_load_dwordx4 v[88:91], v14, s[12:15], s75 offen offset:3072 nt
    s_waitcnt vmcnt(3)
    buffer_load_dwordx4 v[92:95], v14, s[12:15], s75 offen offset:3584 nt
    v_mov_b32 v3, 1
    s_mov_b64 exec, 1
    ds_add_u32 v2, v3 offset:68
    s_mov_b64 exec, -1
L_vlast:
    s_nop 1
    s_add_u32 s30, s6, 1
    s_and_b32 s30, s30, 3
    s_lshl_b32 s7, s4, 2
    s_add_u32 s7, s7, s30
    s_sub_u32 s7, s7, 4
    s_lshl_b32 s30, s4, 1
    s_add_u32 s30, s30, s6
    s_cmp_ge_u32 s4, 2
    s_cselect_b32 s7, s7, s30
    s_mov_b32 s16, s50
    s_mov_b32 s17, s51
    s_mov_b32 s18, 1605632
    s_mov_b32 s19, 0x20000
    v_lshrrev_b32 v3, 3, v0
    v_mul_u32_u24 v3, 28672, v3
    v_and_b32 v1, 7, v0
    v_lshl_add_u32 v1, v1, 4, v3
    s_min_u32 s30, s3, 6
    s_mul_i32 s100, s30, 229376
    s_lshl_b32 s30, s7, 7
    s_add_u32 s100, s100, s30
    s_cmp_eq_u32 s3, 7
    s_cselect_b32 s18, 0, s18
    s_cmp_eq_u32 s28, 2
    s_cselect_b32 s18, 0, s18
    v_mov_b32_dpp v16, v96 row_ror:4 row_mask:0xf bank_mask:0x1
    v_mov_b32_dpp v17, v97 row_ror:4 row_mask:0xf bank_mask:0x1
    v_mov_b32_dpp v18, v98 row_ror:4 row_mask:0xf bank_mask:0x1
    v_mov_b32_dpp v19, v99 row_ror:4 row_mask:0xf bank_mask:0x1
    v_mov_b32_dpp v20, v96 row_ror:8 row_mask:0xf bank_mask:0x2
    v_mov_b32_dpp v21, v97 row_ror:8 row_mask:0xf bank_mask:0x2
    v_mov_b32_dpp v22, v98 row_ror:8 row_mask:0xf bank_mask:0x2
    v_mov_b32_dpp v23, v99 row_ror:8 row_mask:0xf bank_mask:0x2
    v_mov_b32_dpp v24, v96 row_ror:12 row_mask:0xf bank_mask:0x4
    v_mov_b32_dpp v25, v97 row_ror:12 row_mask:0xf bank_mask:0x4
    v_mov_b32_dpp v26, v98 row_ror:12 row_mask:0xf bank_mask:0x4
    v_mov_b32_dpp v27, v99 row_ror:12 row_mask:0xf bank_mask:0x4
    v_mov_b32_dpp v28, v96 quad_perm:[0,1,2,3] row_mask:0xf bank_mask:0x8
    v_mov_b32_dpp v29, v97 quad_perm:[0,1,2,3] row_mask:0xf bank_mask:0x8
    v_mov_b32_dpp v30, v98 quad_perm:[0,1,2,3] row_mask:0xf bank_mask:0x8
    v_mov_b32_dpp v31, v99 quad_perm:[0,1,2,3] row_mask:0xf bank_mask:0x8
    v_lshlrev_b32 v3, 3, v0
L_st_tail:
    s_waitcnt vmcnt(6)
    v_perm_b32 v32, v68, v64, s64
    v_perm_b32 v36, v68, v64, s65
    v_perm_b32 v40, v69, v65, s64
    v_perm_b32 v44, v69, v65, s65
    v_perm_b32 v48, v70, v66, s64
    v_perm_b32 v52, v70, v66, s65
    v_perm_b32 v56, v71, v67, s64
    v_perm_b32 v60, v71, v67, s65
    s_waitcnt vmcnt(4)
    v_perm_b32 v33, v76, v72, s64
    v_perm_b32 v37, v76, v72, s65
    v_perm_b32 v41, v77, v73, s64
    v_perm_b32 v45, v77, v73, s65
    v_perm_b32 v49, v78, v74, s64
    v_perm_b32 v53, v78, v74, s65
    v_perm_b32 v57, v79, v75, s64
    v_perm_b32 v61, v79, v75, s65
    s_waitcnt vmcnt(2)
    v_perm_b32 v34, v84, v80, s64
    v_perm_b32 v38, v84, v80, s65
    v_perm_b32 v42, v85, v81, s64
    v_perm_b32 v46, v85, v81, s65
    v_perm_b32 v50, v86, v82, s64
    v_perm_b32 v54, v86, v82, s65
    v_perm_b32 v58, v87, v83, s64
    v_perm_b32 v62, v87, v83, s65
    s_waitcnt vmcnt(0)
    v_perm_b32 v35, v92, v88, s64
    v_perm_b32 v39, v92, v88, s65
    v_perm_b32 v43, v93, v89, s64
    v_perm_b32 v47, v93, v89, s65
    v_perm_b32 v51, v94, v90, s64
    v_perm_b32 v55, v94, v90, s65
    v_perm_b32 v59, v95, v91, s64
    v_perm_b32 v63, v95, v91, s65
    v_mfma_f32_16x16x32_bf16 v[100:103], v[16:19], v[32:35], v[100:103]
    v_mfma_f32_16x16x32_bf16 v[104:107], v[16:19], v[48:51], v[104:107]
    v_mfma_f32_16x16x32_bf16 v[100:103], v[20:23], v[36:39], v[100:103]
    v_mfma_f32_16x16x32_bf16 v[104:107], v[20:23], v[52:55], v[104:107]
    v_mfma_f32_16x16x32_bf16 v[100:103], v[24:27], v[40:43], v[100:103]
    v_mfma_f32_16x16x32_bf16 v[104:107], v[24:27], v[56:59], v[104:107]
    v_mfma_f32_16x16x32_bf16 v[100:103], v[28:31], v[44:47], v[100:103]
    v_mfma_f32_16x16x32_bf16 v[104:107], v[28:31], v[60:63], v[104:107]
    s_nop 6
    v_add_f32_dpp v108, v102, v100 row_ror:8 row_mask:0xf bank_mask:0x3
    v_add_f32_dpp v109, v103, v101 row_ror:8 row_mask:0xf bank_mask:0x3
    s_nop 0
    v_add_f32_dpp v108, v104, v106 row_ror:8 row_mask:0xf bank_mask:0xc
    v_add_f32_dpp v109, v105, v107 row_ror:8 row_mask:0xf bank_mask:0xc
    v_cvt_f64_f32 v[112:113], v108
    ds_add_f64 v3, v[112:113] offset:256
    v_cvt_f64_f32 v[114:115], v109
    ds_add_f64 v3, v[114:115] offset:768
    s_cbranch_execz g_13
    v_mov_b32 v4, 1
    s_mov_b64 exec, 1
    ds_add_u32 v2, v4 offset:72
    s_mov_b64 exec, -1
g_13:
    s_cbranch_execz up_14
    s_cmp_eq_u32 s28, 2
    s_cbranch_scc1 L_st_end
    s_cmp_eq_u32 s3, 7
    s_cbranch_scc1 L_st_end
    buffer_load_dwordx4 v[64:67], v1, s[16:19], s100 offen
    s_add_u32 s100, s100, 3584
    buffer_load_dwordx4 v[68:71], v1, s[16:19], s100 offen
    s_add_u32 s100, s100, 3584
    buffer_load_dwordx4 v[72:75], v1, s[16:19], s100 offen
    s_add_u32 s100, s100, 3584
    buffer_load_dwordx4 v[76:79], v1, s[16:19], s100 offen
    s_add_u32 s100, s100, 3584
    buffer_load_dwordx4 v[80:83], v1, s[16:19], s100 offen
    s_add_u32 s100, s100, 3584
    buffer_load_dwordx4 v[84:87], v1, s[16:19], s100 offen
    s_add_u32 s100, s100, 3584
    buffer_load_dwordx4 v[88:91], v1, s[16:19], s100 offen
    s_add_u32 s100, s100, 3584
    buffer_load_dwordx4 v[92:95], v1, s[16:19], s100 offen
up_14:
    s_cbranch_execz g_15
    s_barrier
g_15:
    s_lshl_b32 s33, s3, 13
    s_add_u32 s33, s33, 32768
    v_lshlrev_b32 v3, 4, v0
    v_add_u32 v3, s33, v3
    ds_read_b128 v[32:35], v3 offset:0
    ds_read_b128 v[36:39], v3 offset:1024
    ds_read_b128 v[40:43], v3 offset:2048
    ds_read_b128 v[44:47], v3 offset:3072
    ds_read_b128 v[48:51], v3 offset:4096
    ds_read_b128 v[52:55], v3 offset:5120
    ds_read_b128 v[56:59], v3 offset:6144
    ds_read_b128 v[60:63], v3 offset:7168
    v_lshrrev_b32 v3, 4, v0
    v_and_b32 v4, 1, v0
    v_lshl_add_u32 v3, v3, 1, v4
    v_bfe_u32 v4, v0, 1, 2
    v_lshlrev_b32 v4, 1, v4
    v_lshl_add_u32 v12, v3, 3, v4
    s_lshl_b32 s30, s3, 6
    v_add_u32 v13, s30, v12
    v_lshlrev_b32 v3, 1, v13
    ds_read_b32 v14, v3 offset:6016
    ds_read_b32 v16, v3 offset:6912
    v_lshlrev_b32 v13, 2, v13
    v_and_b32 v3, 7, v0
    v_cmp_gt_u32 vcc, 7, v3
    s_nop 1
    v_cndmask_b32 v18, 0, v3, vcc
    v_mov_b32 v4, 0x3e124925
    v_cndmask_b32 v20, 0, v4, vcc
    v_mov_b32 v4, 0x3b124925
    v_cndmask_b32 v21, 0, v4, vcc
    v_lshlrev_b32 v19, 8, v18
    v_lshlrev_b32 v18, 3, v18
    v_lshlrev_b32 v22, 3, v0
    s_waitcnt lgkmcnt(0)
    v_and_b32 v15, s66, v14
    v_lshlrev_b32 v14, 16, v14
    v_and_b32 v17, s66, v16
    v_lshlrev_b32 v16, 16, v16
    v_add_f32 v16, 1.0, v16
    v_add_f32 v17, 1.0, v17
    v_cvt_pk_bf16_f32 v3, v16, v17
    v_lshlrev_b32 v16, 16, v3
    v_and_b32 v17, s66, v3
    v_perm_b32 v4, v36, v32, s64
    v_perm_b32 v36, v36, v32, s65
    v_mov_b32 v32, v4
    v_perm_b32 v4, v37, v33, s64
    v_perm_b32 v5, v37, v33, s65
    v_perm_b32 v33, v44, v40, s64
    v_perm_b32 v37, v44, v40, s65
    v_mov_b32 v40, v4
    v_mov_b32 v44, v5
    v_perm_b32 v4, v38, v34, s64
    v_perm_b32 v5, v38, v34, s65
    v_perm_b32 v34, v52, v48, s64
    v_perm_b32 v38, v52, v48, s65
    v_mov_b32 v48, v4
    v_mov_b32 v52, v5
    v_perm_b32 v4, v39, v35, s64
    v_perm_b32 v5, v39, v35, s65
    v_perm_b32 v35, v60, v56, s64
    v_perm_b32 v39, v60, v56, s65
    v_mov_b32 v56, v4
    v_mov_b32 v60, v5
    v_perm_b32 v4, v45, v41, s64
    v_perm_b32 v45, v45, v41, s65
    v_mov_b32 v41, v4
    v_perm_b32 v4, v46, v42, s64
    v_perm_b32 v5, v46, v42, s65
    v_perm_b32 v42, v53, v49, s64
    v_perm_b32 v46, v53, v49, s65
    v_mov_b32 v49, v4
    v_mov_b32 v53, v5
    v_perm_b32 v4, v47, v43, s64
    v_perm_b32 v5, v47, v43, s65
    v_perm_b32 v43, v61, v57, s64
    v_perm_b32 v47, v61, v57, s65
    v_mov_b32 v57, v4
    v_mov_b32 v61, v5
    v_perm_b32 v4, v54, v50, s64
    v_perm_b32 v54, v54, v50, s65
    v_mov_b32 v50, v4
    v_perm_b32 v4, v55, v51, s64
    v_perm_b32 v5, v55, v51, s65
    v_perm_b32 v51, v62, v58, s64
    v_perm_b32 v55, v62, v58, s65
    v_mov_b32 v58, v4
    v_mov_b32 v62, v5
    v_perm_b32 v4, v63, v59, s64
    v_perm_b32 v63, v63, v59, s65
    v_mov_b32 v59, v4
    s_waitcnt vmcnt(0)
    v_perm_b32 v4, v68, v64, s64
    v_perm_b32 v68, v68, v64, s65
    v_mov_b32 v64, v4
    v_perm_b32 v4, v69, v65, s64
    v_perm_b32 v5, v69, v65, s65
    v_perm_b32 v65, v76, v72, s64
    v_perm_b32 v69, v76, v72, s65
    v_mov_b32 v72, v4
    v_mov_b32 v76, v5
    v_perm_b32 v4, v70, v66, s64
    v_perm_b32 v5, v70, v66, s65
    v_perm_b32 v66, v84, v80, s64
    v_perm_b32 v70, v84, v80, s65
    v_mov_b32 v80, v4
    v_mov_b32 v84, v5
    v_perm_b32 v4, v71, v67, s64
    v_perm_b32 v5, v71, v67, s65
    v_perm_b32 v67, v92, v88, s64
    v_perm_b32 v71, v92, v88, s65
    v_mov_b32 v88, v4
    v_mov_b32 v92, v5
    v_perm_b32 v4, v77, v73, s64
    v_perm_b32 v77, v77, v73, s65
    v_mov_b32 v73, v4
    v_perm_b32 v4, v78, v74, s64
    v_perm_b32 v5, v78, v74, s65
    v_perm_b32 v74, v85, v81, s64
    v_perm_b32 v78, v85, v81, s65
    v_mov_b32 v81, v4
    v_mov_b32 v85, v5
    v_perm_b32 v4, v79, v75, s64
    v_perm_b32 v5, v79, v75, s65
    v_perm_b32 v75, v93, v89, s64
    v_perm_b32 v79, v93, v89, s65
    v_mov_b32 v89, v4
    v_mov_b32 v93, v5
    v_perm_b32 v4, v86, v82, s64
    v_perm_b32 v86, v86, v82, s65
    v_mov_b32 v82, v4
    v_perm_b32 v4, v87, v83, s64
    v_perm_b32 v5, v87, v83, s65
    v_perm_b32 v83, v94, v90, s64
    v_perm_b32 v87, v94, v90, s65
    v_mov_b32 v90, v4
    v_mov_b32 v94, v5
    v_perm_b32 v4, v95, v91, s64
    v_perm_b32 v95, v95, v91, s65
    v_mov_b32 v91, v4
    s_cbranch_execz g_16
    s_setprio 3
g_16:
    s_cbranch_execz g_17
    s_barrier
g_17:
    ds_read_b64 v[24:25], v18 offset:128
    ds_read_b32 v26, v19 offset:2304
    ds_read_b64 v[28:29], v13 offset:2304
    s_waitcnt lgkmcnt(1)
    v_mul_f32 v3, 0x3c800000, v24
    v_add_f32 v26, v26, v3
    v_fma_f32 v25, -v3, v24, v25
    v_mul_f32 v27, v26, v20
    s_nop 1
    v_add_f32_dpp v27, v27, v27 row_ror:1 row_mask:0xf bank_mask:0xf
    s_nop 1
    v_add_f32_dpp v27, v27, v27 row_ror:2 row_mask:0xf bank_mask:0xf
    s_nop 1
    v_add_f32_dpp v27, v27, v27 row_ror:4 row_mask:0xf bank_mask:0xf
    v_sub_f32 v26, v26, v27
    v_mul_f32 v26, v26, v26
    v_fmac_f32 v25, 0x42800000, v26
    v_mul_f32 v25, v25, v21
    s_waitcnt lgkmcnt(0)
    v_cvt_pk_bf16_f32 v27, v27, v27
    v_add_f32_dpp v25, v25, v25 row_ror:1 row_mask:0xf bank_mask:0xf
    v_lshlrev_b32 v27, 16, v27
    v_sub_f32 v28, v28, v27
    v_add_f32_dpp v25, v25, v25 row_ror:2 row_mask:0xf bank_mask:0xf
    v_sub_f32 v29, v29, v27
    v_cvt_pk_bf16_f32 v3, v28, v29
    v_add_f32_dpp v25, v25, v25 row_ror:4 row_mask:0xf bank_mask:0xf
    v_lshlrev_b32 v28, 16, v3
    v_and_b32 v29, s66, v3
    v_cvt_pk_bf16_f32 v25, v25, v25
    v_lshlrev_b32 v25, 16, v25
    v_add_f32 v25, 0x3727c5ac, v25
    v_cvt_pk_bf16_f32 v25, v25, v25
    v_lshlrev_b32 v25, 16, v25
    v_sqrt_f32 v25, v25
    s_nop 0
    v_cvt_pk_bf16_f32 v25, v25, v25
    v_lshlrev_b32 v25, 16, v25
    v_rcp_f32 v25, v25
    s_nop 0
    v_mul_f32 v28, v28, v25
    v_mul_f32 v29, v29, v25
    v_cvt_pk_bf16_f32 v3, v28, v29
    v_lshlrev_b32 v28, 16, v3
    v_and_b32 v29, s66, v3
    v_mul_f32 v28, v28, v16
    v_mul_f32 v29, v29, v17
    v_cvt_pk_bf16_f32 v3, v28, v29
    v_lshlrev_b32 v28, 16, v3
    v_and_b32 v29, s66, v3
    v_add_f32 v28, v28, v14
    v_add_f32 v29, v29, v15
    v_cvt_pk_bf16_f32 v24, v28, v29
    s_nop 1
    v_mov_b32_dpp v25, v24 row_ror:14 row_mask:0xf bank_mask:0xf
    v_mov_b32_dpp v26, v24 row_ror:12 row_mask:0xf bank_mask:0xf
    v_mov_b32_dpp v27, v24 row_ror:10 row_mask:0xf bank_mask:0xf
    s_nop 1
    v_mfma_f32_16x16x32_bf16 v[32:35], v[24:27], v[32:35], 0
    v_mfma_f32_16x16x32_bf16 v[40:43], v[24:27], v[40:43], 0
    v_mfma_f32_16x16x32_bf16 v[48:51], v[24:27], v[48:51], 0
    v_mfma_f32_16x16x32_bf16 v[56:59], v[24:27], v[56:59], 0
    v_mfma_f32_16x16x32_bf16 v[36:39], v[24:27], v[36:39], 0
    v_mfma_f32_16x16x32_bf16 v[44:47], v[24:27], v[44:47], 0
    v_mfma_f32_16x16x32_bf16 v[52:55], v[24:27], v[52:55], 0
    v_mfma_f32_16x16x32_bf16 v[60:63], v[24:27], v[60:63], 0
    v_mfma_f32_16x16x32_bf16 v[64:67], v[24:27], v[64:67], 0
    v_add_f32_dpp v28, v33, v32 row_ror:8 row_mask:0x1 bank_mask:0x3
    v_mfma_f32_16x16x32_bf16 v[72:75], v[24:27], v[72:75], 0
    v_add_f32_dpp v29, v41, v40 row_ror:8 row_mask:0x1 bank_mask:0x3
    v_mfma_f32_16x16x32_bf16 v[80:83], v[24:27], v[80:83], 0
    v_add_f32_dpp v28, v49, v48 row_ror:8 row_mask:0x4 bank_mask:0x3
    v_mfma_f32_16x16x32_bf16 v[88:91], v[24:27], v[88:91], 0
    v_add_f32_dpp v29, v57, v56 row_ror:8 row_mask:0x4 bank_mask:0x3
    v_mfma_f32_16x16x32_bf16 v[68:71], v[24:27], v[68:71], 0
    v_add_f32_dpp v28, v36, v37 row_ror:8 row_mask:0x1 bank_mask:0xc
    v_mfma_f32_16x16x32_bf16 v[76:79], v[24:27], v[76:79], 0
    v_add_f32_dpp v29, v44, v45 row_ror:8 row_mask:0x1 bank_mask:0xc
    v_mfma_f32_16x16x32_bf16 v[84:87], v[24:27], v[84:87], 0
    v_add_f32_dpp v28, v52, v53 row_ror:8 row_mask:0x4 bank_mask:0xc
    v_mfma_f32_16x16x32_bf16 v[92:95], v[24:27], v[92:95], 0
    v_add_f32_dpp v29, v60, v61 row_ror:8 row_mask:0x4 bank_mask:0xc
    s_nop 1
    v_permlane16_swap_b32 v28, v29
    v_cvt_f64_f32 v[4:5], v28
    ds_add_f64 v22, v[4:5] offset:1280
    v_add_f32_dpp v30, v65, v64 row_ror:8 row_mask:0x1 bank_mask:0x3
    v_add_f32_dpp v31, v73, v72 row_ror:8 row_mask:0x1 bank_mask:0x3
    s_nop 0
    v_add_f32_dpp v30, v81, v80 row_ror:8 row_mask:0x4 bank_mask:0x3
    v_add_f32_dpp v31, v89, v88 row_ror:8 row_mask:0x4 bank_mask:0x3
    s_nop 0
    v_add_f32_dpp v30, v68, v69 row_ror:8 row_mask:0x1 bank_mask:0xc
    v_add_f32_dpp v31, v76, v77 row_ror:8 row_mask:0x1 bank_mask:0xc
    s_nop 0
    v_add_f32_dpp v30, v84, v85 row_ror:8 row_mask:0x4 bank_mask:0xc
    v_add_f32_dpp v31, v92, v93 row_ror:8 row_mask:0x4 bank_mask:0xc
    s_nop 1
    v_permlane16_swap_b32 v30, v31
    v_cvt_f64_f32 v[6:7], v30
    ds_add_f64 v22, v[6:7] offset:1792
    s_waitcnt lgkmcnt(0)
    s_cbranch_execz g_18
    s_barrier
g_18:
    s_cbranch_execz L_svc_tail
L_st_end:
    s_endpgm
.p2align 9
L_notstream:
    s_lshl_b32 s30, s4, 3
    s_add_u32 s30, s30, s5
    s_cmp_ge_u32 s4, 2
    s_cbranch_scc0 pr_19
    s_mul_i32 s29, s5, 6
    s_add_u32 s29, s29, s4
    s_add_u32 s29, s29, 14
    s_lshl_b32 s31, s6, 8
    s_add_u32 s31, s31, s29
    s_cmp_lt_u32 s31, 32
    s_cselect_b32 s79, 1, 0
    s_cmp_eq_u32 s5, 3
    s_cselect_b32 s31, 9, s6
    s_cmp_eq_u32 s31, 1
    s_cselect_b32 s29, s30, s29
    s_cselect_b32 s79, 2, s79
    s_branch pr_20
pr_19:
    s_lshl_b32 s29, s5, 1
    s_add_u32 s29, s29, s4
    s_cmp_eq_u32 s6, 0
    s_cselect_b32 s79, 1, 0
    s_cmp_eq_u32 s6, 2
    s_cselect_b32 s29, s30, s29
    s_cselect_b32 s79, 2, s79
    s_cmp_eq_u32 s6, 3
    s_cbranch_scc0 pr_20
    s_lshl_b32 s29, s30, 3
    s_add_u32 s29, s29, 19
    s_add_u32 s31, s30, 26
    s_cmp_lt_u32 s30, 6
    s_cselect_b32 s29, s29, s31
    s_cselect_b32 s79, 2, 1
pr_20:
    s_cmp_eq_u32 s3, 15
    s_cbranch_scc1 L_comm
    s_sub_u32 s3, s3, 8
    s_cmp_eq_u32 s79, 1
    s_cbranch_scc0 L_svc_nh
    v_lshrrev_b32 v3, 3, v0
    v_mul_u32_u24 v3, 43008, v3
    v_and_b32 v1, 7, v0
    v_lshl_add_u32 v1, v1, 4, v3
    s_mul_i32 s34, s3, 344064
    s_lshl_b32 s30, s29, 7
    s_add_u32 s34, s34, s30
    s_setprio 2
    s_waitcnt lgkmcnt(0)
    s_mov_b32 s68, s56
    s_mov_b32 s69, s57
    s_mov_b32 s70, 2408448
    s_mov_b32 s71, 0x20000
    buffer_load_dwordx4 v[96:99], v1, s[68:71], s34 offen nt
    s_add_u32 s34, s34, 5376
    buffer_load_dwordx4 v[100:103], v1, s[68:71], s34 offen nt
    s_add_u32 s34, s34, 5376
    buffer_load_dwordx4 v[104:107], v1, s[68:71], s34 offen nt
    s_add_u32 s34, s34, 5376
    buffer_load_dwordx4 v[108:111], v1, s[68:71], s34 offen nt
    s_add_u32 s34, s34, 5376
    buffer_load_dwordx4 v[112:115], v1, s[68:71], s34 offen nt
    s_add_u32 s34, s34, 5376
    buffer_load_dwordx4 v[116:119], v1, s[68:71], s34 offen nt
    s_add_u32 s34, s34, 5376
    buffer_load_dwordx4 v[120:123], v1, s[68:71], s34 offen nt
    s_add_u32 s34, s34, 5376
    buffer_load_dwordx4 v[124:127], v1, s[68:71], s34 offen nt
L_svc_nh:
    s_barrier
    s_waitcnt lgkmcnt(0)
    s_mov_b32 s24, s62
    s_mov_b32 s25, s63
    s_mov_b32 s26, 0x200000
    s_mov_b32 s27, 0x20000
    s_add_u32 s30, s6, 1
    s_and_b32 s30, s30, 3
    s_lshl_b32 s7, s4, 2
    s_add_u32 s7, s7, s30
    s_sub_u32 s7, s7, 4
    s_lshl_b32 s30, s4, 1
    s_add_u32 s30, s30, s6
    s_cmp_ge_u32 s4, 2
    s_cselect_b32 s7, s7, s30
    s_cmp_eq_u32 s79, 0
    s_cbranch_scc1 L_svc_w
    v_lshrrev_b32 v3, 4, v0
    v_lshlrev_b32 v3, 1, v3
    v_and_b32 v4, 1, v0
    v_add_u32 v3, v3, v4
    v_lshlrev_b32 v6, 4, v3
    s_lshl_b32 s30, s3, 7
    v_add_u32 v6, s30, v6
    v_bfe_u32 v7, v0, 1, 3
    v_lshlrev_b32 v31, 4, v0
    v_mul_u32_u24 v30, 896, v7
    v_add_u32 v30, v30, v6
    s_setprio 2
    s_cmp_eq_u32 s79, 2
    s_cbranch_scc1 L_svc_P
    s_mov_b32 s8, s54
    s_mov_b32 s9, s55
    s_mov_b32 s10, 7168
    s_mov_b32 s11, 0x20000
    buffer_load_dwordx4 v[8:11], v30, s[8:11], 0 offen
    s_mov_b32 s30, 692224
    buffer_load_dword v5, v2, s[24:27], s30 offen sc1
    v_mov_b32 v3, 1
    s_mov_b64 exec, 1
    ds_add_u32 v2, v3 offset:8
    s_mov_b64 exec, -1
    s_cmp_ge_u32 s3, 4
    s_cbranch_scc1 H_ret
    s_mov_b64 exec, 0
    s_cmp_eq_u32 s3, 0
    s_cbranch_scc1 H_s0
    s_cmp_eq_u32 s3, 1
    s_cbranch_scc1 H_s1
    s_cmp_eq_u32 s3, 2
    s_cbranch_scc1 H_s2
    s_branch H_sR
H_ret:
    s_nop 7
    s_mov_b64 exec, -1
H_s0:
    s_cbranch_execz gw_21
    s_waitcnt vmcnt(1)
gw_21:
    v_lshlrev_b32 v16, 16, v8
    v_and_b32 v17, s66, v8
    v_lshlrev_b32 v18, 16, v9
    v_and_b32 v19, s66, v9
    v_lshlrev_b32 v20, 16, v10
    v_and_b32 v21, s66, v10
    v_lshlrev_b32 v22, 16, v11
    v_and_b32 v23, s66, v11
    v_mul_f32 v24, 0xbfb8aa3b, v16
    v_mul_f32 v25, 0xbfb8aa3b, v17
    v_mul_f32 v26, 0xbfb8aa3b, v18
    v_mul_f32 v27, 0xbfb8aa3b, v19
    v_mul_f32 v8, 0xbfb8aa3b, v20
    v_mul_f32 v9, 0xbfb8aa3b, v21
    v_mul_f32 v10, 0xbfb8aa3b, v22
    v_mul_f32 v11, 0xbfb8aa3b, v23
    v_exp_f32 v24, v24
    v_exp_f32 v25, v25
    v_exp_f32 v26, v26
    v_exp_f32 v27, v27
    v_exp_f32 v8, v8
    v_exp_f32 v9, v9
    v_exp_f32 v10, v10
    v_exp_f32 v11, v11
    v_add_f32 v24, 1.0, v24
    v_add_f32 v25, 1.0, v25
    v_add_f32 v26, 1.0, v26
    v_add_f32 v27, 1.0, v27
    v_add_f32 v8, 1.0, v8
    v_add_f32 v9, 1.0, v9
    v_add_f32 v10, 1.0, v10
    v_add_f32 v11, 1.0, v11
    v_rcp_f32 v24, v24
    v_rcp_f32 v25, v25
    v_rcp_f32 v26, v26
    v_rcp_f32 v27, v27
    v_rcp_f32 v8, v8
    v_rcp_f32 v9, v9
    v_rcp_f32 v10, v10
    v_rcp_f32 v11, v11
    v_mul_f32 v16, v16, v24
    v_mul_f32 v17, v17, v25
    v_mul_f32 v18, v18, v26
    v_mul_f32 v19, v19, v27
    v_mul_f32 v20, v20, v8
    v_mul_f32 v21, v21, v9
    v_mul_f32 v22, v22, v10
    v_mul_f32 v23, v23, v11
    v_cvt_pk_bf16_f32 v12, v16, v17
    v_cvt_pk_bf16_f32 v13, v18, v19
    v_cvt_pk_bf16_f32 v14, v20, v21
    v_cvt_pk_bf16_f32 v15, v22, v23
    s_cbranch_execz H_ret
H_sT:
    s_waitcnt vmcnt(0)
    v_readfirstlane_b32 s78, v5
    s_nop 0
    s_add_u32 s78, s78, 0x9e3779b9
    v_mov_b32 v3, 1
    s_mov_b64 exec, 1
    ds_add_u32 v2, v3 offset:28
    s_mov_b64 exec, -1
H_s1:
    v_perm_b32 v4, v100, v96, s64
    v_perm_b32 v100, v100, v96, s65
    v_mov_b32 v96, v4
    v_perm_b32 v4, v101, v97, s64
    v_perm_b32 v5, v101, v97, s65
    v_perm_b32 v97, v108, v104, s64
    v_perm_b32 v101, v108, v104, s65
    v_mov_b32 v104, v4
    v_mov_b32 v108, v5
    v_perm_b32 v4, v102, v98, s64
    v_perm_b32 v5, v102, v98, s65
    v_perm_b32 v98, v116, v112, s64
    v_perm_b32 v102, v116, v112, s65
    v_mov_b32 v112, v4
    v_mov_b32 v116, v5
    v_perm_b32 v4, v103, v99, s64
    v_perm_b32 v5, v103, v99, s65
    v_perm_b32 v99, v124, v120, s64
    v_perm_b32 v103, v124, v120, s65
    v_mov_b32 v120, v4
    v_mov_b32 v124, v5
    v_perm_b32 v4, v109, v105, s64
    v_perm_b32 v109, v109, v105, s65
    v_mov_b32 v105, v4
    v_perm_b32 v4, v110, v106, s64
    v_perm_b32 v5, v110, v106, s65
    v_perm_b32 v106, v117, v113, s64
    v_perm_b32 v110, v117, v113, s65
    v_mov_b32 v113, v4
    v_mov_b32 v117, v5
    v_perm_b32 v4, v111, v107, s64
    v_perm_b32 v5, v111, v107, s65
    v_perm_b32 v107, v125, v121, s64
    v_perm_b32 v111, v125, v121, s65
    v_mov_b32 v121, v4
    v_mov_b32 v125, v5
    v_perm_b32 v4, v118, v114, s64
    v_perm_b32 v118, v118, v114, s65
    v_mov_b32 v114, v4
    v_perm_b32 v4, v119, v115, s64
    v_perm_b32 v5, v119, v115, s65
    v_perm_b32 v115, v126, v122, s64
    v_perm_b32 v119, v126, v122, s65
    v_mov_b32 v122, v4
    v_mov_b32 v126, v5
    v_perm_b32 v4, v127, v123, s64
    v_perm_b32 v127, v127, v123, s65
    v_mov_b32 v123, v4
    s_cbranch_execz H_ret
H_s2:
    v_mfma_f32_16x16x32_bf16 v[64:67], v[12:15], v[96:99], 0
    v_mfma_f32_16x16x32_bf16 v[68:71], v[12:15], v[100:103], 0
    v_mfma_f32_16x16x32_bf16 v[72:75], v[12:15], v[104:107], 0
    v_mfma_f32_16x16x32_bf16 v[76:79], v[12:15], v[108:111], 0
    v_mfma_f32_16x16x32_bf16 v[80:83], v[12:15], v[112:115], 0
    v_mfma_f32_16x16x32_bf16 v[84:87], v[12:15], v[116:119], 0
    v_mfma_f32_16x16x32_bf16 v[88:91], v[12:15], v[120:123], 0
    v_mfma_f32_16x16x32_bf16 v[92:95], v[12:15], v[124:127], 0
    s_lshl_b32 s30, s3, 11
    v_add_u32 v3, s30, v31
    v_add_f32_dpp v16, v65, v64 row_ror:8 row_mask:0xf bank_mask:0x3
    v_add_f32_dpp v17, v69, v68 row_ror:8 row_mask:0xf bank_mask:0x3
    v_add_f32_dpp v18, v73, v72 row_ror:8 row_mask:0xf bank_mask:0x3
    v_add_f32_dpp v19, v77, v76 row_ror:8 row_mask:0xf bank_mask:0x3
    v_add_f32_dpp v20, v81, v80 row_ror:8 row_mask:0xf bank_mask:0x3
    v_add_f32_dpp v21, v85, v84 row_ror:8 row_mask:0xf bank_mask:0x3
    v_add_f32_dpp v22, v89, v88 row_ror:8 row_mask:0xf bank_mask:0x3
    v_add_f32_dpp v23, v93, v92 row_ror:8 row_mask:0xf bank_mask:0x3
    v_add_f32_dpp v16, v66, v67 row_ror:8 row_mask:0xf bank_mask:0xc
    v_add_f32_dpp v17, v70, v71 row_ror:8 row_mask:0xf bank_mask:0xc
    v_add_f32_dpp v18, v74, v75 row_ror:8 row_mask:0xf bank_mask:0xc
    v_add_f32_dpp v19, v78, v79 row_ror:8 row_mask:0xf bank_mask:0xc
    v_add_f32_dpp v20, v82, v83 row_ror:8 row_mask:0xf bank_mask:0xc
    v_add_f32_dpp v21, v86, v87 row_ror:8 row_mask:0xf bank_mask:0xc
    v_add_f32_dpp v22, v90, v91 row_ror:8 row_mask:0xf bank_mask:0xc
    v_add_f32_dpp v23, v94, v95 row_ror:8 row_mask:0xf bank_mask:0xc
    ds_write_b128 v3, v[16:19] offset:18432
    ds_write_b128 v3, v[20:23] offset:19456
    v_mov_b32 v3, 1
    s_waitcnt lgkmcnt(0)
    s_cbranch_execz H_ret
H_sX:
    s_mov_b64 exec, 1
    ds_add_u32 v2, v3 offset:16
    s_mov_b64 exec, -1
    s_cmp_lg_u32 s3, 0
    s_cbranch_scc1 H_done
    v_lshrrev_b32 v4, 3, v0
    v_mul_u32_u24 v4, 5376, v4
    v_and_b32 v5, 7, v0
    v_lshl_add_u32 v4, v5, 4, v4
spin_22:
    ds_read_b32 v3, v2 offset:16
    s_waitcnt lgkmcnt(0)
    v_readfirstlane_b32 s30, v3
    s_nop 0
    s_cmp_ge_u32 s30, 7
    s_cbranch_scc1 spind_23
    s_branch spin_22
spind_23:
H_sR:
    ds_read_b128 v[32:35], v31 offset:18432
    ds_read_b128 v[36:39], v31 offset:19456
    ds_read_b128 v[40:43], v31 offset:20480
    ds_read_b128 v[44:47], v31 offset:21504
    ds_read_b128 v[48:51], v31 offset:22528
    ds_read_b128 v[52:55], v31 offset:23552
    ds_read_b128 v[56:59], v31 offset:24576
    ds_read_b128 v[60:63], v31 offset:25600
    ds_read_b128 v[64:67], v31 offset:26624
    ds_read_b128 v[68:71], v31 offset:27648
    ds_read_b128 v[72:75], v31 offset:28672
    ds_read_b128 v[76:79], v31 offset:29696
    ds_read_b128 v[80:83], v31 offset:30720
    ds_read_b128 v[84:87], v31 offset:31744
    s_lshl_b32 s33, s29, 7
    s_add_u32 s33, s33, 0
    s_add_u32 s32, s33, 1638400
    s_waitcnt lgkmcnt(10)
    v_pk_add_f32 v[32:33], v[32:33], v[40:41]
    v_pk_add_f32 v[34:35], v[34:35], v[42:43]
    v_pk_add_f32 v[36:37], v[36:37], v[44:45]
    v_pk_add_f32 v[38:39], v[38:39], v[46:47]
    s_waitcnt lgkmcnt(6)
    v_pk_add_f32 v[48:49], v[48:49], v[56:57]
    v_pk_add_f32 v[50:51], v[50:51], v[58:59]
    v_pk_add_f32 v[52:53], v[52:53], v[60:61]
    v_pk_add_f32 v[54:55], v[54:55], v[62:63]
    s_waitcnt lgkmcnt(2)
    v_pk_add_f32 v[64:65], v[64:65], v[72:73]
    v_pk_add_f32 v[66:67], v[66:67], v[74:75]
    v_pk_add_f32 v[68:69], v[68:69], v[76:77]
    v_pk_add_f32 v[70:71], v[70:71], v[78:79]
    s_waitcnt lgkmcnt(0)
    v_pk_add_f32 v[32:33], v[32:33], v[48:49]
    v_pk_add_f32 v[34:35], v[34:35], v[50:51]
    v_pk_add_f32 v[36:37], v[36:37], v[52:53]
    v_pk_add_f32 v[38:39], v[38:39], v[54:55]
    v_pk_add_f32 v[64:65], v[64:65], v[80:81]
    v_pk_add_f32 v[66:67], v[66:67], v[82:83]
    v_pk_add_f32 v[68:69], v[68:69], v[84:85]
    v_pk_add_f32 v[70:71], v[70:71], v[86:87]
    v_pk_add_f32 v[32:33], v[32:33], v[64:65]
    v_pk_add_f32 v[34:35], v[34:35], v[66:67]
    v_pk_add_f32 v[36:37], v[36:37], v[68:69]
    v_pk_add_f32 v[38:39], v[38:39], v[70:71]
    v_cvt_pk_bf16_f32 v24, v32, v33
    v_cvt_pk_bf16_f32 v25, v34, v35
    v_cvt_pk_bf16_f32 v26, v36, v37
    v_cvt_pk_bf16_f32 v27, v38, v39
    v_xor_b32 v16, s78, v24
    v_xor_b32 v17, s78, v25
    v_xor_b32 v18, s78, v26
    v_xor_b32 v19, s78, v27
    s_cbranch_execz H_ret
H_sY:
    buffer_store_dwordx4 v[24:27], v4, s[24:27], s33 offen sc1
    buffer_store_dwordx4 v[16:19], v4, s[24:27], s32 offen sc1
H_done:
    s_branch L_svc_w
L_svc_P:
    s_mov_b32 s72, s42
    s_mov_b32 s73, s43
    s_mov_b32 s74, 3670016
    s_mov_b32 s75, 0x20000
    s_mov_b32 s96, s36
    s_mov_b32 s97, s37
    s_mov_b32 s98, 7168
    s_mov_b32 s99, 0x20000
    buffer_load_dwordx4 v[8:11], v30, s[96:99], 0 offen
    s_mov_b32 s30, 692224
    buffer_load_dword v5, v2, s[24:27], s30 offen sc1
    v_lshrrev_b32 v3, 3, v0
    v_mul_u32_u24 v3, 65536, v3
    v_and_b32 v1, 7, v0
    v_lshl_add_u32 v1, v1, 4, v3
    s_mul_i32 s34, s3, 524288
    s_lshl_b32 s30, s29, 7
    s_add_u32 s34, s34, s30
    s_waitcnt vmcnt(7)
    buffer_load_dwordx4 v[96:99], v1, s[72:75], s34 offen nt
    s_add_u32 s34, s34, 8192
    s_waitcnt vmcnt(7)
    buffer_load_dwordx4 v[100:103], v1, s[72:75], s34 offen nt
    s_add_u32 s34, s34, 8192
    s_waitcnt vmcnt(7)
    buffer_load_dwordx4 v[104:107], v1, s[72:75], s34 offen nt
    s_add_u32 s34, s34, 8192
    s_waitcnt vmcnt(7)
    buffer_load_dwordx4 v[108:111], v1, s[72:75], s34 offen nt
    s_add_u32 s34, s34, 8192
    s_waitcnt vmcnt(7)
    buffer_load_dwordx4 v[112:115], v1, s[72:75], s34 offen nt
    s_add_u32 s34, s34, 8192
    s_waitcnt vmcnt(7)
    buffer_load_dwordx4 v[116:119], v1, s[72:75], s34 offen nt
    s_add_u32 s34, s34, 8192
    s_waitcnt vmcnt(7)
    buffer_load_dwordx4 v[120:123], v1, s[72:75], s34 offen nt
    s_add_u32 s34, s34, 8192
    s_waitcnt vmcnt(7)
    buffer_load_dwordx4 v[124:127], v1, s[72:75], s34 offen nt
    s_waitcnt vmcnt(8)
    v_readfirstlane_b32 s78, v5
    s_nop 0
    s_add_u32 s78, s78, 0x9e3779b9
    v_mov_b32 v3, 1
    s_mov_b64 exec, 1
    ds_add_u32 v2, v3 offset:28
    s_mov_b64 exec, -1
    v_lshlrev_b32 v16, 16, v8
    v_and_b32 v17, s66, v8
    v_lshlrev_b32 v18, 16, v9
    v_and_b32 v19, s66, v9
    v_lshlrev_b32 v20, 16, v10
    v_and_b32 v21, s66, v10
    v_lshlrev_b32 v22, 16, v11
    v_and_b32 v23, s66, v11
    v_add_f32 v24, v16, v17
    v_add_f32 v24, v24, v18
    v_add_f32 v24, v24, v19
    v_add_f32 v24, v24, v20
    v_add_f32 v24, v24, v21
    v_add_f32 v24, v24, v22
    v_add_f32 v24, v24, v23
    s_nop 1
    v_add_f32_dpp v24, v24, v24 quad_perm:[1,0,3,2] row_mask:0xf bank_mask:0xf
    v_mov_b32 v3, v24
    s_nop 1
    v_permlane16_swap_b32 v3, v24
    v_add_f32 v24, v24, v3
    v_mov_b32 v3, v24
    s_nop 1
    v_permlane32_swap_b32 v3, v24
    v_add_f32 v24, v24, v3
    v_mul_f32 v24, 0x3c800000, v24
    v_mov_b32 v25, 0
    v_sub_f32 v3, v16, v24
    v_fmac_f32 v25, v3, v3
    v_sub_f32 v3, v17, v24
    v_fmac_f32 v25, v3, v3
    v_sub_f32 v3, v18, v24
    v_fmac_f32 v25, v3, v3
    v_sub_f32 v3, v19, v24
    v_fmac_f32 v25, v3, v3
    v_sub_f32 v3, v20, v24
    v_fmac_f32 v25, v3, v3
    v_sub_f32 v3, v21, v24
    v_fmac_f32 v25, v3, v3
    v_sub_f32 v3, v22, v24
    v_fmac_f32 v25, v3, v3
    v_sub_f32 v3, v23, v24
    v_fmac_f32 v25, v3, v3
    s_nop 1
    v_add_f32_dpp v25, v25, v25 quad_perm:[1,0,3,2] row_mask:0xf bank_mask:0xf
    v_mov_b32 v3, v25
    s_nop 1
    v_permlane16_swap_b32 v3, v25
    v_add_f32 v25, v25, v3
    v_mov_b32 v3, v25
    s_nop 1
    v_permlane32_swap_b32 v3, v25
    v_add_f32 v25, v25, v3
    s_lshl_b32 s30, s3, 3
    v_lshlrev_b32 v26, 6, v7
    v_add_u32 v3, s30, v26
    ds_write_b64 v3, v[24:25] offset:2304
    v_lshrrev_b32 v3, 4, v0
    v_and_b32 v4, 1, v0
    v_lshl_add_u32 v27, v3, 1, v4
    v_lshl_add_u32 v26, v27, 3, v26
    v_cmp_gt_u32 vcc, 7, v27
    v_mov_b32 v4, 0x42800000
    s_nop 0
    v_cndmask_b32 v27, 0, v4, vcc
    s_waitcnt lgkmcnt(0)
    v_mov_b32 v3, 1
    s_mov_b64 exec, 1
    ds_add_u32 v2, v3 offset:52
    s_mov_b64 exec, -1
spin_24:
    ds_read_b32 v3, v2 offset:52
    s_waitcnt lgkmcnt(0)
    v_readfirstlane_b32 s30, v3
    s_nop 0
    s_cmp_ge_u32 s30, 7
    s_cbranch_scc1 spind_25
    s_branch spin_24
spind_25:
    ds_read_b64 v[28:29], v26 offset:2304
    s_waitcnt lgkmcnt(0)
    v_mov_b32 v24, v28
    s_nop 1
    v_add_f32_dpp v24, v24, v24 quad_perm:[1,0,3,2] row_mask:0xf bank_mask:0xf
    v_mov_b32 v3, v24
    s_nop 1
    v_permlane16_swap_b32 v3, v24
    v_add_f32 v24, v24, v3
    v_mov_b32 v3, v24
    s_nop 1
    v_permlane32_swap_b32 v3, v24
    v_add_f32 v24, v24, v3
    v_mul_f32 v24, 0x3e124925, v24
    v_sub_f32 v28, v28, v24
    v_mul_f32 v28, v28, v28
    v_fma_f32 v25, v28, v27, v29
    s_nop 1
    v_add_f32_dpp v25, v25, v25 quad_perm:[1,0,3,2] row_mask:0xf bank_mask:0xf
    v_mov_b32 v3, v25
    s_nop 1
    v_permlane16_swap_b32 v3, v25
    v_add_f32 v25, v25, v3
    v_mov_b32 v3, v25
    s_nop 1
    v_permlane32_swap_b32 v3, v25
    v_add_f32 v25, v25, v3
    v_mul_f32 v25, 0x3b124925, v25
    v_cvt_pk_bf16_f32 v3, v24, v25
    v_lshlrev_b32 v24, 16, v3
    v_and_b32 v25, s66, v3
    v_add_f32 v25, 0x3727c5ac, v25
    v_cvt_pk_bf16_f32 v25, v25, v25
    v_lshlrev_b32 v25, 16, v25
    v_sqrt_f32 v25, v25
    s_nop 0
    v_cvt_pk_bf16_f32 v25, v25, v25
    v_lshlrev_b32 v25, 16, v25
    v_rcp_f32 v25, v25
    v_sub_f32 v16, v16, v24
    v_sub_f32 v17, v17, v24
    v_sub_f32 v18, v18, v24
    v_sub_f32 v19, v19, v24
    v_sub_f32 v20, v20, v24
    v_sub_f32 v21, v21, v24
    v_sub_f32 v22, v22, v24
    v_sub_f32 v23, v23, v24
    v_cvt_pk_bf16_f32 v3, v16, v17
    v_lshlrev_b32 v16, 16, v3
    v_and_b32 v17, s66, v3
    v_cvt_pk_bf16_f32 v3, v18, v19
    v_lshlrev_b32 v18, 16, v3
    v_and_b32 v19, s66, v3
    v_cvt_pk_bf16_f32 v3, v20, v21
    v_lshlrev_b32 v20, 16, v3
    v_and_b32 v21, s66, v3
    v_cvt_pk_bf16_f32 v3, v22, v23
    v_lshlrev_b32 v22, 16, v3
    v_and_b32 v23, s66, v3
    v_mul_f32 v16, v16, v25
    v_mul_f32 v17, v17, v25
    v_mul_f32 v18, v18, v25
    v_mul_f32 v19, v19, v25
    v_mul_f32 v20, v20, v25
    v_mul_f32 v21, v21, v25
    v_mul_f32 v22, v22, v25
    v_mul_f32 v23, v23, v25
    v_cvt_pk_bf16_f32 v8, v16, v17
    v_cvt_pk_bf16_f32 v9, v18, v19
    v_cvt_pk_bf16_f32 v10, v20, v21
    v_cvt_pk_bf16_f32 v11, v22, v23
    s_cmp_ge_u32 s3, 3
    s_cbranch_scc1 Q_ret
    s_mov_b64 exec, 0
    s_cmp_eq_u32 s3, 0
    s_cbranch_scc1 Q_s0
    s_cmp_eq_u32 s3, 1
    s_cbranch_scc1 Q_s2
    s_branch Q_sR
Q_ret:
    s_nop 7
    s_mov_b64 exec, -1
    s_waitcnt vmcnt(0)
    v_perm_b32 v4, v100, v96, s64
    v_perm_b32 v100, v100, v96, s65
    v_mov_b32 v96, v4
    v_perm_b32 v4, v101, v97, s64
    v_perm_b32 v5, v101, v97, s65
    v_perm_b32 v97, v108, v104, s64
    v_perm_b32 v101, v108, v104, s65
    v_mov_b32 v104, v4
    v_mov_b32 v108, v5
    v_perm_b32 v4, v102, v98, s64
    v_perm_b32 v5, v102, v98, s65
    v_perm_b32 v98, v116, v112, s64
    v_perm_b32 v102, v116, v112, s65
    v_mov_b32 v112, v4
    v_mov_b32 v116, v5
    v_perm_b32 v4, v103, v99, s64
    v_perm_b32 v5, v103, v99, s65
    v_perm_b32 v99, v124, v120, s64
    v_perm_b32 v103, v124, v120, s65
    v_mov_b32 v120, v4
    v_mov_b32 v124, v5
    v_perm_b32 v4, v109, v105, s64
    v_perm_b32 v109, v109, v105, s65
    v_mov_b32 v105, v4
    v_perm_b32 v4, v110, v106, s64
    v_perm_b32 v5, v110, v106, s65
    v_perm_b32 v106, v117, v113, s64
    v_perm_b32 v110, v117, v113, s65
    v_mov_b32 v113, v4
    v_mov_b32 v117, v5
    v_perm_b32 v4, v111, v107, s64
    v_perm_b32 v5, v111, v107, s65
    v_perm_b32 v107, v125, v121, s64
    v_perm_b32 v111, v125, v121, s65
    v_mov_b32 v121, v4
    v_mov_b32 v125, v5
    v_perm_b32 v4, v118, v114, s64
    v_perm_b32 v118, v118, v114, s65
    v_mov_b32 v114, v4
    v_perm_b32 v4, v119, v115, s64
    v_perm_b32 v5, v119, v115, s65
    v_perm_b32 v115, v126, v122, s64
    v_perm_b32 v119, v126, v122, s65
    v_mov_b32 v122, v4
    v_mov_b32 v126, v5
    v_perm_b32 v4, v127, v123, s64
    v_perm_b32 v127, v127, v123, s65
    v_mov_b32 v123, v4
    v_mul_u32_u24 v30, 5376, v7
    v_add_u32 v30, v30, v6
    s_mov_b32 s32, 1638400
    s_mov_b32 s31, 0
pollx_26:
    buffer_load_dwordx4 v[16:19], v30, s[24:27], 0 offen offset:0 sc1
    buffer_load_dwordx4 v[20:23], v30, s[24:27], 0 offen offset:896 sc1
    buffer_load_dwordx4 v[32:35], v30, s[24:27], s32 offen offset:0 sc1
    buffer_load_dwordx4 v[36:39], v30, s[24:27], s32 offen offset:896 sc1
    s_waitcnt vmcnt(0)
    v_xor_b32 v32, v16, v32
    v_xor_b32 v32, s78, v32
    v_xor_b32 v33, v17, v33
    v_xor_b32 v33, s78, v33
    v_or_b32 v32, v32, v33
    v_xor_b32 v34, v18, v34
    v_xor_b32 v34, s78, v34
    v_or_b32 v32, v32, v34
    v_xor_b32 v35, v19, v35
    v_xor_b32 v35, s78, v35
    v_or_b32 v32, v32, v35
    v_xor_b32 v36, v20, v36
    v_xor_b32 v36, s78, v36
    v_or_b32 v32, v32, v36
    v_xor_b32 v37, v21, v37
    v_xor_b32 v37, s78, v37
    v_or_b32 v32, v32, v37
    v_xor_b32 v38, v22, v38
    v_xor_b32 v38, s78, v38
    v_or_b32 v32, v32, v38
    v_xor_b32 v39, v23, v39
    v_xor_b32 v39, s78, v39
    v_or_b32 v32, v32, v39
    v_cmp_ne_u32 vcc, 0, v32
    s_cbranch_vccz pollxd_27
    s_add_u32 s31, s31, 1
    s_cmp_lt_u32 s31, 1048576
    s_cbranch_scc1 pollx_26
pollxd_27:
Q_s0:
    v_lshlrev_b32 v28, 16, v20
    v_and_b32 v29, s66, v20
    v_add_f32 v28, 1.0, v28
    v_add_f32 v29, 1.0, v29
    v_cvt_pk_bf16_f32 v3, v28, v29
    v_lshlrev_b32 v28, 16, v3
    v_and_b32 v29, s66, v3
    v_lshlrev_b32 v24, 16, v8
    v_and_b32 v25, s66, v8
    v_mul_f32 v24, v24, v28
    v_mul_f32 v25, v25, v29
    v_cvt_pk_bf16_f32 v3, v24, v25
    v_lshlrev_b32 v24, 16, v3
    v_and_b32 v25, s66, v3
    v_lshlrev_b32 v28, 16, v16
    v_and_b32 v29, s66, v16
    v_add_f32 v24, v24, v28
    v_add_f32 v25, v25, v29
    v_cvt_pk_bf16_f32 v12, v24, v25
    v_lshlrev_b32 v28, 16, v21
    v_and_b32 v29, s66, v21
    v_add_f32 v28, 1.0, v28
    v_add_f32 v29, 1.0, v29
    v_cvt_pk_bf16_f32 v3, v28, v29
    v_lshlrev_b32 v28, 16, v3
    v_and_b32 v29, s66, v3
    v_lshlrev_b32 v24, 16, v9
    v_and_b32 v25, s66, v9
    v_mul_f32 v24, v24, v28
    v_mul_f32 v25, v25, v29
    v_cvt_pk_bf16_f32 v3, v24, v25
    v_lshlrev_b32 v24, 16, v3
    v_and_b32 v25, s66, v3
    v_lshlrev_b32 v28, 16, v17
    v_and_b32 v29, s66, v17
    v_add_f32 v24, v24, v28
    v_add_f32 v25, v25, v29
    v_cvt_pk_bf16_f32 v13, v24, v25
    v_lshlrev_b32 v28, 16, v22
    v_and_b32 v29, s66, v22
    v_add_f32 v28, 1.0, v28
    v_add_f32 v29, 1.0, v29
    v_cvt_pk_bf16_f32 v3, v28, v29
    v_lshlrev_b32 v28, 16, v3
    v_and_b32 v29, s66, v3
    v_lshlrev_b32 v24, 16, v10
    v_and_b32 v25, s66, v10
    v_mul_f32 v24, v24, v28
    v_mul_f32 v25, v25, v29
    v_cvt_pk_bf16_f32 v3, v24, v25
    v_lshlrev_b32 v24, 16, v3
    v_and_b32 v25, s66, v3
    v_lshlrev_b32 v28, 16, v18
    v_and_b32 v29, s66, v18
    v_add_f32 v24, v24, v28
    v_add_f32 v25, v25, v29
    v_cvt_pk_bf16_f32 v14, v24, v25
    v_lshlrev_b32 v28, 16, v23
    v_and_b32 v29, s66, v23
    v_add_f32 v28, 1.0, v28
    v_add_f32 v29, 1.0, v29
    v_cvt_pk_bf16_f32 v3, v28, v29
    v_lshlrev_b32 v28, 16, v3
    v_and_b32 v29, s66, v3
    v_lshlrev_b32 v24, 16, v11
    v_and_b32 v25, s66, v11
    v_mul_f32 v24, v24, v28
    v_mul_f32 v25, v25, v29
    v_cvt_pk_bf16_f32 v3, v24, v25
    v_lshlrev_b32 v24, 16, v3
    v_and_b32 v25, s66, v3
    v_lshlrev_b32 v28, 16, v19
    v_and_b32 v29, s66, v19
    v_add_f32 v24, v24, v28
    v_add_f32 v25, v25, v29
    v_cvt_pk_bf16_f32 v15, v24, v25
    s_cbranch_execz Q_ret
Q_s2:
    s_nop 0
    v_mfma_f32_16x16x32_bf16 v[64:67], v[12:15], v[96:99], 0
    v_mfma_f32_16x16x32_bf16 v[68:71], v[12:15], v[100:103], 0
    v_mfma_f32_16x16x32_bf16 v[72:75], v[12:15], v[104:107], 0
    v_mfma_f32_16x16x32_bf16 v[76:79], v[12:15], v[108:111], 0
    v_mfma_f32_16x16x32_bf16 v[80:83], v[12:15], v[112:115], 0
    v_mfma_f32_16x16x32_bf16 v[84:87], v[12:15], v[116:119], 0
    v_mfma_f32_16x16x32_bf16 v[88:91], v[12:15], v[120:123], 0
    v_mfma_f32_16x16x32_bf16 v[92:95], v[12:15], v[124:127], 0
    s_lshl_b32 s30, s3, 11
    v_add_u32 v3, s30, v31
    v_add_f32_dpp v16, v65, v64 row_ror:8 row_mask:0xf bank_mask:0x3
    v_add_f32_dpp v17, v69, v68 row_ror:8 row_mask:0xf bank_mask:0x3
    v_add_f32_dpp v18, v73, v72 row_ror:8 row_mask:0xf bank_mask:0x3
    v_add_f32_dpp v19, v77, v76 row_ror:8 row_mask:0xf bank_mask:0x3
    v_add_f32_dpp v20, v81, v80 row_ror:8 row_mask:0xf bank_mask:0x3
    v_add_f32_dpp v21, v85, v84 row_ror:8 row_mask:0xf bank_mask:0x3
    v_add_f32_dpp v22, v89, v88 row_ror:8 row_mask:0xf bank_mask:0x3
    v_add_f32_dpp v23, v93, v92 row_ror:8 row_mask:0xf bank_mask:0x3
    v_add_f32_dpp v16, v66, v67 row_ror:8 row_mask:0xf bank_mask:0xc
    v_add_f32_dpp v17, v70, v71 row_ror:8 row_mask:0xf bank_mask:0xc
    v_add_f32_dpp v18, v74, v75 row_ror:8 row_mask:0xf bank_mask:0xc
    v_add_f32_dpp v19, v78, v79 row_ror:8 row_mask:0xf bank_mask:0xc
    v_add_f32_dpp v20, v82, v83 row_ror:8 row_mask:0xf bank_mask:0xc
    v_add_f32_dpp v21, v86, v87 row_ror:8 row_mask:0xf bank_mask:0xc
    v_add_f32_dpp v22, v90, v91 row_ror:8 row_mask:0xf bank_mask:0xc
    v_add_f32_dpp v23, v94, v95 row_ror:8 row_mask:0xf bank_mask:0xc
    ds_write_b128 v3, v[16:19] offset:18432
    ds_write_b128 v3, v[20:23] offset:19456
    v_mov_b32 v3, 1
    s_waitcnt lgkmcnt(0)
    s_cbranch_execz Q_ret
Q_sX:
    s_mov_b64 exec, 1
    ds_add_u32 v2, v3 offset:16
    s_mov_b64 exec, -1
    s_cmp_lg_u32 s3, 0
    s_cbranch_scc1 Q_done
    v_lshrrev_b32 v4, 3, v0
    v_mul_u32_u24 v4, 8192, v4
    v_and_b32 v5, 7, v0
    v_lshl_add_u32 v4, v5, 4, v4
spin_28:
    ds_read_b32 v3, v2 offset:16
    s_waitcnt lgkmcnt(0)
    v_readfirstlane_b32 s30, v3
    s_nop 0
    s_cmp_ge_u32 s30, 7
    s_cbranch_scc1 spind_29
    s_branch spin_28
spind_29:
Q_sR:
    ds_read_b128 v[32:35], v31 offset:18432
    ds_read_b128 v[36:39], v31 offset:19456
    ds_read_b128 v[40:43], v31 offset:20480
    ds_read_b128 v[44:47], v31 offset:21504
    ds_read_b128 v[48:51], v31 offset:22528
    ds_read_b128 v[52:55], v31 offset:23552
    ds_read_b128 v[56:59], v31 offset:24576
    ds_read_b128 v[60:63], v31 offset:25600
    ds_read_b128 v[64:67], v31 offset:26624
    ds_read_b128 v[68:71], v31 offset:27648
    ds_read_b128 v[72:75], v31 offset:28672
    ds_read_b128 v[76:79], v31 offset:29696
    ds_read_b128 v[80:83], v31 offset:30720
    ds_read_b128 v[84:87], v31 offset:31744
    s_lshl_b32 s33, s29, 7
    s_add_u32 s33, s33, 65536
    s_add_u32 s32, s33, 1638400
    s_waitcnt lgkmcnt(10)
    v_pk_add_f32 v[32:33], v[32:33], v[40:41]
    v_pk_add_f32 v[34:35], v[34:35], v[42:43]
    v_pk_add_f32 v[36:37], v[36:37], v[44:45]
    v_pk_add_f32 v[38:39], v[38:39], v[46:47]
    s_waitcnt lgkmcnt(6)
    v_pk_add_f32 v[48:49], v[48:49], v[56:57]
    v_pk_add_f32 v[50:51], v[50:51], v[58:59]
    v_pk_add_f32 v[52:53], v[52:53], v[60:61]
    v_pk_add_f32 v[54:55], v[54:55], v[62:63]
    s_waitcnt lgkmcnt(2)
    v_pk_add_f32 v[64:65], v[64:65], v[72:73]
    v_pk_add_f32 v[66:67], v[66:67], v[74:75]
    v_pk_add_f32 v[68:69], v[68:69], v[76:77]
    v_pk_add_f32 v[70:71], v[70:71], v[78:79]
    s_waitcnt lgkmcnt(0)
    v_pk_add_f32 v[32:33], v[32:33], v[48:49]
    v_pk_add_f32 v[34:35], v[34:35], v[50:51]
    v_pk_add_f32 v[36:37], v[36:37], v[52:53]
    v_pk_add_f32 v[38:39], v[38:39], v[54:55]
    v_pk_add_f32 v[64:65], v[64:65], v[80:81]
    v_pk_add_f32 v[66:67], v[66:67], v[82:83]
    v_pk_add_f32 v[68:69], v[68:69], v[84:85]
    v_pk_add_f32 v[70:71], v[70:71], v[86:87]
    v_pk_add_f32 v[32:33], v[32:33], v[64:65]
    v_pk_add_f32 v[34:35], v[34:35], v[66:67]
    v_pk_add_f32 v[36:37], v[36:37], v[68:69]
    v_pk_add_f32 v[38:39], v[38:39], v[70:71]
    v_cvt_pk_bf16_f32 v24, v32, v33
    v_cvt_pk_bf16_f32 v25, v34, v35
    v_cvt_pk_bf16_f32 v26, v36, v37
    v_cvt_pk_bf16_f32 v27, v38, v39
    v_xor_b32 v16, s78, v24
    v_xor_b32 v17, s78, v25
    v_xor_b32 v18, s78, v26
    v_xor_b32 v19, s78, v27
    s_cbranch_execz Q_ret
Q_sY:
    buffer_store_dwordx4 v[24:27], v4, s[24:27], s33 offen sc1
    buffer_store_dwordx4 v[16:19], v4, s[24:27], s32 offen sc1
Q_done:
L_svc_w:
    s_setprio 1
    s_waitcnt vmcnt(0)
    s_mov_b32 s8, s44
    s_mov_b32 s9, s45
    s_mov_b32 s10, 3670016
    s_mov_b32 s11, 0x20000
    s_mov_b32 s12, s52
    s_mov_b32 s13, s53
    s_mov_b32 s14, 1605632
    s_mov_b32 s15, 0x20000
    s_mov_b32 s16, s48
    s_mov_b32 s17, s49
    s_mov_b32 s18, 1605632
    s_mov_b32 s19, 0x20000
    v_lshrrev_b32 v3, 3, v0
    v_mul_u32_u24 v3, 7168, v3
    v_and_b32 v1, 7, v0
    v_lshl_add_u32 v1, v1, 4, v3
    v_lshrrev_b32 v3, 3, v0
    v_mul_u32_u24 v3, 28672, v3
    v_and_b32 v8, 7, v0
    v_lshl_add_u32 v8, v8, 4, v3
    s_lshl_b32 s30, s4, 9
    s_lshl_b32 s31, s6, 6
    s_add_u32 s30, s30, s31
    s_mul_i32 s34, s30, 896
    s_lshl_b32 s31, s3, 7
    s_add_u32 s34, s34, s31
    s_add_u32 s35, s34, 229376
    s_mul_i32 s100, s7, 57344
    s_add_u32 s100, s100, s31
    s_mov_b32 s77, 0
    s_cmp_eq_u32 s28, 2
    s_cbranch_scc0 L_svc_mlp
    s_cmp_ge_u32 s77, 8
    s_cbranch_scc1 ff_30
    s_waitcnt vmcnt(1)
    ds_read_b32 v3, v2 offset:68
    s_waitcnt lgkmcnt(0)
    v_readfirstlane_b32 s77, v3
ff_30:
    buffer_load_dwordx4 v[32:35], v1, s[8:11], s34 offen
    s_add_u32 s34, s34, 896
    s_cmp_ge_u32 s77, 8
    s_cbranch_scc1 ff_31
    s_waitcnt vmcnt(1)
    ds_read_b32 v3, v2 offset:68
    s_waitcnt lgkmcnt(0)
    v_readfirstlane_b32 s77, v3
ff_31:
    buffer_load_dwordx4 v[36:39], v1, s[8:11], s34 offen
    s_add_u32 s34, s34, 896
    s_cmp_ge_u32 s77, 8
    s_cbranch_scc1 ff_32
    s_waitcnt vmcnt(1)
    ds_read_b32 v3, v2 offset:68
    s_waitcnt lgkmcnt(0)
    v_readfirstlane_b32 s77, v3
ff_32:
    buffer_load_dwordx4 v[40:43], v1, s[8:11], s34 offen
    s_add_u32 s34, s34, 896
    s_cmp_ge_u32 s77, 8
    s_cbranch_scc1 ff_33
    s_waitcnt vmcnt(1)
    ds_read_b32 v3, v2 offset:68
    s_waitcnt lgkmcnt(0)
    v_readfirstlane_b32 s77, v3
ff_33:
    buffer_load_dwordx4 v[44:47], v1, s[8:11], s34 offen
    s_add_u32 s34, s34, 896
    s_cmp_ge_u32 s77, 8
    s_cbranch_scc1 ff_34
    s_waitcnt vmcnt(1)
    ds_read_b32 v3, v2 offset:68
    s_waitcnt lgkmcnt(0)
    v_readfirstlane_b32 s77, v3
ff_34:
    buffer_load_dwordx4 v[48:51], v1, s[8:11], s34 offen
    s_add_u32 s34, s34, 896
    s_cmp_ge_u32 s77, 8
    s_cbranch_scc1 ff_35
    s_waitcnt vmcnt(1)
    ds_read_b32 v3, v2 offset:68
    s_waitcnt lgkmcnt(0)
    v_readfirstlane_b32 s77, v3
ff_35:
    buffer_load_dwordx4 v[52:55], v1, s[8:11], s34 offen
    s_add_u32 s34, s34, 896
    s_cmp_ge_u32 s77, 8
    s_cbranch_scc1 ff_36
    s_waitcnt vmcnt(1)
    ds_read_b32 v3, v2 offset:68
    s_waitcnt lgkmcnt(0)
    v_readfirstlane_b32 s77, v3
ff_36:
    buffer_load_dwordx4 v[56:59], v1, s[8:11], s34 offen
    s_add_u32 s34, s34, 896
    s_cmp_ge_u32 s77, 8
    s_cbranch_scc1 ff_37
    s_waitcnt vmcnt(1)
    ds_read_b32 v3, v2 offset:68
    s_waitcnt lgkmcnt(0)
    v_readfirstlane_b32 s77, v3
ff_37:
    buffer_load_dwordx4 v[60:63], v1, s[8:11], s34 offen
    s_cmp_ge_u32 s77, 8
    s_cbranch_scc1 ff_38
    s_waitcnt vmcnt(1)
    ds_read_b32 v3, v2 offset:68
    s_waitcnt lgkmcnt(0)
    v_readfirstlane_b32 s77, v3
ff_38:
    buffer_load_dwordx4 v[64:67], v1, s[8:11], s35 offen
    s_add_u32 s35, s35, 896
    s_cmp_ge_u32 s77, 8
    s_cbranch_scc1 ff_39
    s_waitcnt vmcnt(1)
    ds_read_b32 v3, v2 offset:68
    s_waitcnt lgkmcnt(0)
    v_readfirstlane_b32 s77, v3
ff_39:
    buffer_load_dwordx4 v[68:71], v1, s[8:11], s35 offen
    s_add_u32 s35, s35, 896
    s_cmp_ge_u32 s77, 8
    s_cbranch_scc1 ff_40
    s_waitcnt vmcnt(1)
    ds_read_b32 v3, v2 offset:68
    s_waitcnt lgkmcnt(0)
    v_readfirstlane_b32 s77, v3
ff_40:
    buffer_load_dwordx4 v[72:75], v1, s[8:11], s35 offen
    s_add_u32 s35, s35, 896
    s_waitcnt vmcnt(3)
    v_perm_b32 v4, v36, v32, s64
    v_perm_b32 v36, v36, v32, s65
    v_mov_b32 v32, v4
    v_perm_b32 v4, v37, v33, s64
    v_perm_b32 v5, v37, v33, s65
    v_perm_b32 v33, v44, v40, s64
    v_perm_b32 v37, v44, v40, s65
    v_mov_b32 v40, v4
    v_mov_b32 v44, v5
    v_perm_b32 v4, v38, v34, s64
    v_perm_b32 v5, v38, v34, s65
    v_perm_b32 v34, v52, v48, s64
    v_perm_b32 v38, v52, v48, s65
    v_mov_b32 v48, v4
    v_mov_b32 v52, v5
    v_perm_b32 v4, v39, v35, s64
    v_perm_b32 v5, v39, v35, s65
    v_perm_b32 v35, v60, v56, s64
    v_perm_b32 v39, v60, v56, s65
    v_mov_b32 v56, v4
    v_mov_b32 v60, v5
    v_perm_b32 v4, v45, v41, s64
    v_perm_b32 v45, v45, v41, s65
    v_mov_b32 v41, v4
    v_perm_b32 v4, v46, v42, s64
    v_perm_b32 v5, v46, v42, s65
    v_perm_b32 v42, v53, v49, s64
    v_perm_b32 v46, v53, v49, s65
    v_mov_b32 v49, v4
    v_mov_b32 v53, v5
    v_perm_b32 v4, v47, v43, s64
    v_perm_b32 v5, v47, v43, s65
    v_perm_b32 v43, v61, v57, s64
    v_perm_b32 v47, v61, v57, s65
    v_mov_b32 v57, v4
    v_mov_b32 v61, v5
    v_perm_b32 v4, v54, v50, s64
    v_perm_b32 v54, v54, v50, s65
    v_mov_b32 v50, v4
    v_perm_b32 v4, v55, v51, s64
    v_perm_b32 v5, v55, v51, s65
    v_perm_b32 v51, v62, v58, s64
    v_perm_b32 v55, v62, v58, s65
    v_mov_b32 v58, v4
    v_mov_b32 v62, v5
    v_perm_b32 v4, v63, v59, s64
    v_perm_b32 v63, v63, v59, s65
    v_mov_b32 v59, v4
    s_cmp_ge_u32 s77, 8
    s_cbranch_scc1 ff_41
    s_waitcnt vmcnt(1)
    ds_read_b32 v3, v2 offset:68
    s_waitcnt lgkmcnt(0)
    v_readfirstlane_b32 s77, v3
ff_41:
    buffer_load_dwordx4 v[76:79], v1, s[8:11], s35 offen
    s_add_u32 s35, s35, 896
    s_cmp_ge_u32 s77, 8
    s_cbranch_scc1 ff_42
    s_waitcnt vmcnt(1)
    ds_read_b32 v3, v2 offset:68
    s_waitcnt lgkmcnt(0)
    v_readfirstlane_b32 s77, v3
ff_42:
    buffer_load_dwordx4 v[80:83], v1, s[8:11], s35 offen
    s_add_u32 s35, s35, 896
    s_cmp_ge_u32 s77, 8
    s_cbranch_scc1 ff_43
    s_waitcnt vmcnt(1)
    ds_read_b32 v3, v2 offset:68
    s_waitcnt lgkmcnt(0)
    v_readfirstlane_b32 s77, v3
ff_43:
    buffer_load_dwordx4 v[84:87], v1, s[8:11], s35 offen
    s_add_u32 s35, s35, 896
    s_cmp_ge_u32 s77, 8
    s_cbranch_scc1 ff_44
    s_waitcnt vmcnt(1)
    ds_read_b32 v3, v2 offset:68
    s_waitcnt lgkmcnt(0)
    v_readfirstlane_b32 s77, v3
ff_44:
    buffer_load_dwordx4 v[88:91], v1, s[8:11], s35 offen
    s_add_u32 s35, s35, 896
    s_cmp_ge_u32 s77, 8
    s_cbranch_scc1 ff_45
    s_waitcnt vmcnt(1)
    ds_read_b32 v3, v2 offset:68
    s_waitcnt lgkmcnt(0)
    v_readfirstlane_b32 s77, v3
ff_45:
    buffer_load_dwordx4 v[92:95], v1, s[8:11], s35 offen
    s_waitcnt vmcnt(0)
    v_perm_b32 v4, v68, v64, s64
    v_perm_b32 v68, v68, v64, s65
    v_mov_b32 v64, v4
    v_perm_b32 v4, v69, v65, s64
    v_perm_b32 v5, v69, v65, s65
    v_perm_b32 v65, v76, v72, s64
    v_perm_b32 v69, v76, v72, s65
    v_mov_b32 v72, v4
    v_mov_b32 v76, v5
    v_perm_b32 v4, v70, v66, s64
    v_perm_b32 v5, v70, v66, s65
    v_perm_b32 v66, v84, v80, s64
    v_perm_b32 v70, v84, v80, s65
    v_mov_b32 v80, v4
    v_mov_b32 v84, v5
    v_perm_b32 v4, v71, v67, s64
    v_perm_b32 v5, v71, v67, s65
    v_perm_b32 v67, v92, v88, s64
    v_perm_b32 v71, v92, v88, s65
    v_mov_b32 v88, v4
    v_mov_b32 v92, v5
    v_perm_b32 v4, v77, v73, s64
    v_perm_b32 v77, v77, v73, s65
    v_mov_b32 v73, v4
    v_perm_b32 v4, v78, v74, s64
    v_perm_b32 v5, v78, v74, s65
    v_perm_b32 v74, v85, v81, s64
    v_perm_b32 v78, v85, v81, s65
    v_mov_b32 v81, v4
    v_mov_b32 v85, v5
    v_perm_b32 v4, v79, v75, s64
    v_perm_b32 v5, v79, v75, s65
    v_perm_b32 v75, v93, v89, s64
    v_perm_b32 v79, v93, v89, s65
    v_mov_b32 v89, v4
    v_mov_b32 v93, v5
    v_perm_b32 v4, v86, v82, s64
    v_perm_b32 v86, v86, v82, s65
    v_mov_b32 v82, v4
    v_perm_b32 v4, v87, v83, s64
    v_perm_b32 v5, v87, v83, s65
    v_perm_b32 v83, v94, v90, s64
    v_perm_b32 v87, v94, v90, s65
    v_mov_b32 v90, v4
    v_mov_b32 v94, v5
    v_perm_b32 v4, v95, v91, s64
    v_perm_b32 v95, v95, v91, s65
    v_mov_b32 v91, v4
    s_branch L_svc_rdy
L_svc_mlp:
    s_cmp_ge_u32 s77, 8
    s_cbranch_scc1 ff_46
    s_waitcnt vmcnt(1)
    ds_read_b32 v3, v2 offset:68
    s_waitcnt lgkmcnt(0)
    v_readfirstlane_b32 s77, v3
ff_46:
    buffer_load_dwordx4 v[32:35], v1, s[8:11], s34 offen
    s_add_u32 s34, s34, 896
    s_cmp_ge_u32 s77, 8
    s_cbranch_scc1 ff_47
    s_waitcnt vmcnt(1)
    ds_read_b32 v3, v2 offset:68
    s_waitcnt lgkmcnt(0)
    v_readfirstlane_b32 s77, v3
ff_47:
    buffer_load_dwordx4 v[36:39], v1, s[8:11], s34 offen
    s_add_u32 s34, s34, 896
    s_cmp_ge_u32 s77, 8
    s_cbranch_scc1 ff_48
    s_waitcnt vmcnt(1)
    ds_read_b32 v3, v2 offset:68
    s_waitcnt lgkmcnt(0)
    v_readfirstlane_b32 s77, v3
ff_48:
    buffer_load_dwordx4 v[40:43], v1, s[8:11], s34 offen
    s_add_u32 s34, s34, 896
    s_cmp_ge_u32 s77, 8
    s_cbranch_scc1 ff_49
    s_waitcnt vmcnt(1)
    ds_read_b32 v3, v2 offset:68
    s_waitcnt lgkmcnt(0)
    v_readfirstlane_b32 s77, v3
ff_49:
    buffer_load_dwordx4 v[44:47], v1, s[8:11], s34 offen
    s_add_u32 s34, s34, 896
    s_cmp_ge_u32 s77, 8
    s_cbranch_scc1 ff_50
    s_waitcnt vmcnt(1)
    ds_read_b32 v3, v2 offset:68
    s_waitcnt lgkmcnt(0)
    v_readfirstlane_b32 s77, v3
ff_50:
    buffer_load_dwordx4 v[48:51], v1, s[8:11], s34 offen
    s_add_u32 s34, s34, 896
    s_cmp_ge_u32 s77, 8
    s_cbranch_scc1 ff_51
    s_waitcnt vmcnt(1)
    ds_read_b32 v3, v2 offset:68
    s_waitcnt lgkmcnt(0)
    v_readfirstlane_b32 s77, v3
ff_51:
    buffer_load_dwordx4 v[52:55], v1, s[8:11], s34 offen
    s_add_u32 s34, s34, 896
    s_cmp_ge_u32 s77, 8
    s_cbranch_scc1 ff_52
    s_waitcnt vmcnt(1)
    ds_read_b32 v3, v2 offset:68
    s_waitcnt lgkmcnt(0)
    v_readfirstlane_b32 s77, v3
ff_52:
    buffer_load_dwordx4 v[56:59], v1, s[8:11], s34 offen
    s_add_u32 s34, s34, 896
    s_cmp_ge_u32 s77, 8
    s_cbranch_scc1 ff_53
    s_waitcnt vmcnt(1)
    ds_read_b32 v3, v2 offset:68
    s_waitcnt lgkmcnt(0)
    v_readfirstlane_b32 s77, v3
ff_53:
    buffer_load_dwordx4 v[60:63], v1, s[8:11], s34 offen
    s_cmp_ge_u32 s77, 8
    s_cbranch_scc1 ff_54
    s_waitcnt vmcnt(1)
    ds_read_b32 v3, v2 offset:68
    s_waitcnt lgkmcnt(0)
    v_readfirstlane_b32 s77, v3
ff_54:
    buffer_load_dwordx4 v[64:67], v1, s[8:11], s35 offen
    s_add_u32 s35, s35, 896
    s_cmp_ge_u32 s77, 8
    s_cbranch_scc1 ff_55
    s_waitcnt vmcnt(1)
    ds_read_b32 v3, v2 offset:68
    s_waitcnt lgkmcnt(0)
    v_readfirstlane_b32 s77, v3
ff_55:
    buffer_load_dwordx4 v[68:71], v1, s[8:11], s35 offen
    s_add_u32 s35, s35, 896
    s_cmp_ge_u32 s77, 8
    s_cbranch_scc1 ff_56
    s_waitcnt vmcnt(1)
    ds_read_b32 v3, v2 offset:68
    s_waitcnt lgkmcnt(0)
    v_readfirstlane_b32 s77, v3
ff_56:
    buffer_load_dwordx4 v[72:75], v1, s[8:11], s35 offen
    s_add_u32 s35, s35, 896
    s_waitcnt vmcnt(3)
    v_perm_b32 v4, v36, v32, s64
    v_perm_b32 v36, v36, v32, s65
    v_mov_b32 v32, v4
    v_perm_b32 v4, v37, v33, s64
    v_perm_b32 v5, v37, v33, s65
    v_perm_b32 v33, v44, v40, s64
    v_perm_b32 v37, v44, v40, s65
    v_mov_b32 v40, v4
    v_mov_b32 v44, v5
    v_perm_b32 v4, v38, v34, s64
    v_perm_b32 v5, v38, v34, s65
    v_perm_b32 v34, v52, v48, s64
    v_perm_b32 v38, v52, v48, s65
    v_mov_b32 v48, v4
    v_mov_b32 v52, v5
    v_perm_b32 v4, v39, v35, s64
    v_perm_b32 v5, v39, v35, s65
    v_perm_b32 v35, v60, v56, s64
    v_perm_b32 v39, v60, v56, s65
    v_mov_b32 v56, v4
    v_mov_b32 v60, v5
    v_perm_b32 v4, v45, v41, s64
    v_perm_b32 v45, v45, v41, s65
    v_mov_b32 v41, v4
    v_perm_b32 v4, v46, v42, s64
    v_perm_b32 v5, v46, v42, s65
    v_perm_b32 v42, v53, v49, s64
    v_perm_b32 v46, v53, v49, s65
    v_mov_b32 v49, v4
    v_mov_b32 v53, v5
    v_perm_b32 v4, v47, v43, s64
    v_perm_b32 v5, v47, v43, s65
    v_perm_b32 v43, v61, v57, s64
    v_perm_b32 v47, v61, v57, s65
    v_mov_b32 v57, v4
    v_mov_b32 v61, v5
    v_perm_b32 v4, v54, v50, s64
    v_perm_b32 v54, v54, v50, s65
    v_mov_b32 v50, v4
    v_perm_b32 v4, v55, v51, s64
    v_perm_b32 v5, v55, v51, s65
    v_perm_b32 v51, v62, v58, s64
    v_perm_b32 v55, v62, v58, s65
    v_mov_b32 v58, v4
    v_mov_b32 v62, v5
    v_perm_b32 v4, v63, v59, s64
    v_perm_b32 v63, v63, v59, s65
    v_mov_b32 v59, v4
    s_cmp_ge_u32 s77, 8
    s_cbranch_scc1 ff_57
    s_waitcnt vmcnt(1)
    ds_read_b32 v3, v2 offset:68
    s_waitcnt lgkmcnt(0)
    v_readfirstlane_b32 s77, v3
ff_57:
    buffer_load_dwordx4 v[76:79], v1, s[8:11], s35 offen
    s_add_u32 s35, s35, 896
    s_cmp_ge_u32 s77, 8
    s_cbranch_scc1 ff_58
    s_waitcnt vmcnt(1)
    ds_read_b32 v3, v2 offset:68
    s_waitcnt lgkmcnt(0)
    v_readfirstlane_b32 s77, v3
ff_58:
    buffer_load_dwordx4 v[80:83], v1, s[8:11], s35 offen
    s_add_u32 s35, s35, 896
    s_cmp_ge_u32 s77, 8
    s_cbranch_scc1 ff_59
    s_waitcnt vmcnt(1)
    ds_read_b32 v3, v2 offset:68
    s_waitcnt lgkmcnt(0)
    v_readfirstlane_b32 s77, v3
ff_59:
    buffer_load_dwordx4 v[84:87], v1, s[8:11], s35 offen
    s_add_u32 s35, s35, 896
    s_cmp_ge_u32 s77, 8
    s_cbranch_scc1 ff_60
    s_waitcnt vmcnt(1)
    ds_read_b32 v3, v2 offset:68
    s_waitcnt lgkmcnt(0)
    v_readfirstlane_b32 s77, v3
ff_60:
    buffer_load_dwordx4 v[88:91], v1, s[8:11], s35 offen
    s_add_u32 s35, s35, 896
    s_cmp_ge_u32 s77, 8
    s_cbranch_scc1 ff_61
    s_waitcnt vmcnt(1)
    ds_read_b32 v3, v2 offset:68
    s_waitcnt lgkmcnt(0)
    v_readfirstlane_b32 s77, v3
ff_61:
    buffer_load_dwordx4 v[92:95], v1, s[8:11], s35 offen
    s_mul_i32 s101, s3, 229376
    s_lshl_b32 s30, s7, 7
    s_add_u32 s101, s101, s30
    s_lshl_b32 s33, s3, 13
    s_add_u32 s33, s33, 32768
    s_waitcnt vmcnt(0)
    v_perm_b32 v4, v68, v64, s64
    v_perm_b32 v68, v68, v64, s65
    v_mov_b32 v64, v4
    v_perm_b32 v4, v69, v65, s64
    v_perm_b32 v5, v69, v65, s65
    v_perm_b32 v65, v76, v72, s64
    v_perm_b32 v69, v76, v72, s65
    v_mov_b32 v72, v4
    v_mov_b32 v76, v5
    v_perm_b32 v4, v70, v66, s64
    v_perm_b32 v5, v70, v66, s65
    v_perm_b32 v66, v84, v80, s64
    v_perm_b32 v70, v84, v80, s65
    v_mov_b32 v80, v4
    v_mov_b32 v84, v5
    v_perm_b32 v4, v71, v67, s64
    v_perm_b32 v5, v71, v67, s65
    v_perm_b32 v67, v92, v88, s64
    v_perm_b32 v71, v92, v88, s65
    v_mov_b32 v88, v4
    v_mov_b32 v92, v5
    v_perm_b32 v4, v77, v73, s64
    v_perm_b32 v77, v77, v73, s65
    v_mov_b32 v73, v4
    v_perm_b32 v4, v78, v74, s64
    v_perm_b32 v5, v78, v74, s65
    v_perm_b32 v74, v85, v81, s64
    v_perm_b32 v78, v85, v81, s65
    v_mov_b32 v81, v4
    v_mov_b32 v85, v5
    v_perm_b32 v4, v79, v75, s64
    v_perm_b32 v5, v79, v75, s65
    v_perm_b32 v75, v93, v89, s64
    v_perm_b32 v79, v93, v89, s65
    v_mov_b32 v89, v4
    v_mov_b32 v93, v5
    v_perm_b32 v4, v86, v82, s64
    v_perm_b32 v86, v86, v82, s65
    v_mov_b32 v82, v4
    v_perm_b32 v4, v87, v83, s64
    v_perm_b32 v5, v87, v83, s65
    v_perm_b32 v83, v94, v90, s64
    v_perm_b32 v87, v94, v90, s65
    v_mov_b32 v90, v4
    v_mov_b32 v94, v5
    v_perm_b32 v4, v95, v91, s64
    v_perm_b32 v95, v95, v91, s65
    v_mov_b32 v91, v4
    s_mov_b32 s76, s100
    v_mov_b32 v10, v1
L_svc_rdy:
    v_lshrrev_b32 v3, 4, v0
    v_and_b32 v4, 1, v0
    v_lshl_add_u32 v4, v3, 1, v4
    v_bfe_u32 v5, v0, 1, 1
    v_lshlrev_b32 v5, 5, v5
    v_add_u32 v9, v4, v5
    v_bfe_u32 v5, v0, 2, 1
    v_lshl_add_u32 v9, v5, 3, v9
    v_lshlrev_b32 v9, 3, v9
    v_and_b32 v5, 7, v0
    v_lshlrev_b32 v5, 5, v5
    v_lshrrev_b32 v11, 5, v0
    v_lshl_add_u32 v11, v11, 4, v5
    s_lshl_b32 s30, s5, 5
    s_lshl_b32 s31, s4, 2
    s_add_u32 s31, s31, s6
    s_add_u32 s31, s31, s30
    s_mul_i32 s34, s31, 1792
    s_lshl_b32 s33, s3, 8
    s_add_u32 s34, s34, s33
    s_add_u32 s34, s34, 720896
    s_mul_i32 s35, s30, 1792
    s_add_u32 s35, s35, s33
    s_add_u32 s35, s35, 720896
    s_mul_i32 s100, s5, 28
    s_add_u32 s100, s100, s7
    s_mul_i32 s100, s100, 1792
    s_add_u32 s100, s100, s33
    s_add_u32 s100, s100, 1179648
    v_mul_u32_u24 v1, 1792, v3
    v_and_b32 v4, 15, v0
    v_lshl_add_u32 v1, v4, 4, v1
    v_lshl_add_u32 v8, v4, 2, v3
    s_lshl_b32 s30, s3, 6
    v_add_u32 v8, s30, v8
    s_add_u32 s69, s35, 7168
    s_add_u32 s70, s35, 14336
    s_add_u32 s71, s35, 21504
    s_add_u32 s72, s35, 28672
    s_add_u32 s73, s35, 35840
    s_add_u32 s74, s35, 43008
    s_add_u32 s75, s35, 50176
    s_mov_b32 s68, s35
    s_setprio 3
spin_62:
    ds_read_b32 v3, v2 offset:72
    s_waitcnt lgkmcnt(0)
    v_readfirstlane_b32 s30, v3
    s_nop 0
    s_cmp_ge_u32 s30, 8
    s_cbranch_scc1 spind_63
    s_branch spin_62
spind_63:
L_svc_tail:
    ds_read2_b64 v[20:23], v9 offset0:32 offset1:48
    ds_read2_b64 v[24:27], v9 offset0:96 offset1:112
    s_waitcnt lgkmcnt(1)
    v_cvt_f32_f64 v20, v[20:21]
    v_cvt_f32_f64 v22, v[22:23]
    s_waitcnt lgkmcnt(0)
    v_cvt_f32_f64 v24, v[24:25]
    v_cvt_pk_bf16_f32 v12, v20, v22
    v_cvt_f32_f64 v26, v[26:27]
    v_cvt_pk_bf16_f32 v16, v24, v26
    v_mov_b32_dpp v13, v12 row_ror:14 row_mask:0xf bank_mask:0xf
    v_mov_b32_dpp v14, v12 row_ror:12 row_mask:0xf bank_mask:0xf
    v_mov_b32_dpp v15, v12 row_ror:10 row_mask:0xf bank_mask:0xf
    v_mov_b32_dpp v17, v16 row_ror:14 row_mask:0xf bank_mask:0xf
    v_mov_b32_dpp v18, v16 row_ror:12 row_mask:0xf bank_mask:0xf
    v_mov_b32_dpp v19, v16 row_ror:10 row_mask:0xf bank_mask:0xf
    v_mfma_f32_16x16x32_bf16 v[32:35], v[12:15], v[32:35], 0
    v_mfma_f32_16x16x32_bf16 v[36:39], v[12:15], v[36:39], 0
    v_mfma_f32_16x16x32_bf16 v[40:43], v[12:15], v[40:43], 0
    v_mfma_f32_16x16x32_bf16 v[44:47], v[12:15], v[44:47], 0
    v_mfma_f32_16x16x32_bf16 v[48:51], v[12:15], v[48:51], 0
    v_mfma_f32_16x16x32_bf16 v[52:55], v[12:15], v[52:55], 0
    v_mfma_f32_16x16x32_bf16 v[56:59], v[12:15], v[56:59], 0
    v_mfma_f32_16x16x32_bf16 v[60:63], v[12:15], v[60:63], 0
    v_mfma_f32_16x16x32_bf16 v[32:35], v[16:19], v[64:67], v[32:35]
    v_mfma_f32_16x16x32_bf16 v[36:39], v[16:19], v[68:71], v[36:39]
    v_mfma_f32_16x16x32_bf16 v[40:43], v[16:19], v[72:75], v[40:43]
    v_mfma_f32_16x16x32_bf16 v[44:47], v[16:19], v[76:79], v[44:47]
    v_mfma_f32_16x16x32_bf16 v[48:51], v[16:19], v[80:83], v[48:51]
    v_mfma_f32_16x16x32_bf16 v[52:55], v[16:19], v[84:87], v[52:55]
    v_mfma_f32_16x16x32_bf16 v[56:59], v[16:19], v[88:91], v[56:59]
    v_mfma_f32_16x16x32_bf16 v[60:63], v[16:19], v[92:95], v[60:63]
    s_nop 0
    v_add_f32_dpp v20, v33, v32 row_ror:8 row_mask:0x1 bank_mask:0x3
    v_add_f32_dpp v21, v37, v36 row_ror:8 row_mask:0x1 bank_mask:0x3
    v_add_f32_dpp v22, v41, v40 row_ror:8 row_mask:0x1 bank_mask:0x3
    v_add_f32_dpp v23, v45, v44 row_ror:8 row_mask:0x1 bank_mask:0x3
    v_add_f32_dpp v20, v49, v48 row_ror:8 row_mask:0x4 bank_mask:0x3
    v_add_f32_dpp v21, v53, v52 row_ror:8 row_mask:0x4 bank_mask:0x3
    v_add_f32_dpp v22, v57, v56 row_ror:8 row_mask:0x4 bank_mask:0x3
    v_add_f32_dpp v23, v61, v60 row_ror:8 row_mask:0x4 bank_mask:0x3
    s_cbranch_execz g_64
    s_mov_b32 exec_lo, 0xff
    s_mov_b32 exec_hi, 0xff
    buffer_store_dwordx4 v[20:23], v11, s[24:27], s34 offen sc1
    s_mov_b64 exec, -1
g_64:
    s_cbranch_execz notP_65
    s_cmp_lg_u32 s28, 2
    s_cbranch_scc1 notP_65
    s_endpgm
notP_65:
    s_cbranch_execz g_66
    s_barrier
    buffer_load_dwordx4 v[32:35], v1, s[24:27], s68 offen sc1
    buffer_load_dwordx4 v[36:39], v1, s[24:27], s69 offen sc1
    buffer_load_dwordx4 v[40:43], v1, s[24:27], s70 offen sc1
    buffer_load_dwordx4 v[44:47], v1, s[24:27], s71 offen sc1
    buffer_load_dwordx4 v[48:51], v1, s[24:27], s72 offen sc1
    buffer_load_dwordx4 v[52:55], v1, s[24:27], s73 offen sc1
    buffer_load_dwordx4 v[56:59], v1, s[24:27], s74 offen sc1
    buffer_load_dwordx4 v[60:63], v1, s[24:27], s75 offen sc1
g_66:
    v_lshlrev_b32 v3, 1, v8
    ds_read_u16 v23, v3 offset:5120
    ds_read_u16 v24, v3 offset:8704
    v_lshlrev_b32 v25, 2, v8
    v_lshrrev_b32 v26, 5, v0
    v_lshlrev_b32 v26, 2, v26
    s_lshl_b32 s30, s3, 3
    v_add_u32 v26, s30, v26
    v_lshrrev_b32 v12, 4, v0
    v_and_b32 v4, 1, v0
    v_lshl_add_u32 v12, v12, 1, v4
    v_bfe_u32 v4, v0, 1, 2
    v_lshl_add_u32 v12, v4, 4, v12
    v_lshlrev_b32 v12, 3, v12
    v_add_u32 v12, 1280, v12
    s_waitcnt lgkmcnt(0)
    v_lshlrev_b32 v23, 16, v23
    v_lshlrev_b32 v24, 16, v24
    s_mov_b32 s31, 0
    s_cbranch_execz dn_69
    buffer_load_dwordx4 v[96:99], v10, s[12:15], s76 offen
    s_add_u32 s76, s76, 896
    buffer_load_dwordx4 v[100:103], v10, s[12:15], s76 offen
    s_add_u32 s76, s76, 896
    buffer_load_dwordx4 v[104:107], v10, s[12:15], s76 offen
    s_add_u32 s76, s76, 896
    buffer_load_dwordx4 v[108:111], v10, s[12:15], s76 offen
    s_add_u32 s76, s76, 896
    buffer_load_dwordx4 v[112:115], v10, s[12:15], s76 offen
    s_add_u32 s76, s76, 896
    buffer_load_dwordx4 v[116:119], v10, s[12:15], s76 offen
    s_add_u32 s76, s76, 896
    buffer_load_dwordx4 v[120:123], v10, s[12:15], s76 offen
    s_add_u32 s76, s76, 896
    buffer_load_dwordx4 v[124:127], v10, s[12:15], s76 offen
dn_69:
    s_waitcnt vmcnt(8)
    s_branch pa_67_in
pa_67:
    s_waitcnt vmcnt(0)
pa_67_in:
    v_max3_u32 v3, v32, v33, v34
    v_max3_u32 v3, v3, v35, v36
    v_max3_u32 v3, v3, v37, v38
    v_max3_u32 v3, v3, v39, v40
    v_max3_u32 v3, v3, v41, v42
    v_max3_u32 v3, v3, v43, v44
    v_max3_u32 v3, v3, v45, v46
    v_max3_u32 v3, v3, v47, v48
    v_max3_u32 v3, v3, v49, v50
    v_max3_u32 v3, v3, v51, v52
    v_max3_u32 v3, v3, v53, v54
    v_max3_u32 v3, v3, v55, v56
    v_max3_u32 v3, v3, v57, v58
    v_max3_u32 v3, v3, v59, v60
    v_max3_u32 v3, v3, v61, v62
    v_max_u32 v3, v3, v63
    v_cmp_eq_u32 vcc, -1, v3
    s_cbranch_vccz pad_68
    s_add_u32 s31, s31, 1
    s_cmp_ge_u32 s31, 1048576
    s_cbranch_scc1 pad_68
    v_max3_u32 v3, v32, v33, v34
    v_max_u32 v3, v3, v35
    v_cmp_eq_u32 vcc, -1, v3
    s_cbranch_vccz ok_70
    buffer_load_dwordx4 v[32:35], v1, s[24:27], s68 offen sc1
ok_70:
    v_max3_u32 v3, v36, v37, v38
    v_max_u32 v3, v3, v39
    v_cmp_eq_u32 vcc, -1, v3
    s_cbranch_vccz ok_71
    buffer_load_dwordx4 v[36:39], v1, s[24:27], s69 offen sc1
ok_71:
    v_max3_u32 v3, v40, v41, v42
    v_max_u32 v3, v3, v43
    v_cmp_eq_u32 vcc, -1, v3
    s_cbranch_vccz ok_72
    buffer_load_dwordx4 v[40:43], v1, s[24:27], s70 offen sc1
ok_72:
    v_max3_u32 v3, v44, v45, v46
    v_max_u32 v3, v3, v47
    v_cmp_eq_u32 vcc, -1, v3
    s_cbranch_vccz ok_73
    buffer_load_dwordx4 v[44:47], v1, s[24:27], s71 offen sc1
ok_73:
    v_max3_u32 v3, v48, v49, v50
    v_max_u32 v3, v3, v51
    v_cmp_eq_u32 vcc, -1, v3
    s_cbranch_vccz ok_74
    buffer_load_dwordx4 v[48:51], v1, s[24:27], s72 offen sc1
ok_74:
    v_max3_u32 v3, v52, v53, v54
    v_max_u32 v3, v3, v55
    v_cmp_eq_u32 vcc, -1, v3
    s_cbranch_vccz ok_75
    buffer_load_dwordx4 v[52:55], v1, s[24:27], s73 offen sc1
ok_75:
    v_max3_u32 v3, v56, v57, v58
    v_max_u32 v3, v3, v59
    v_cmp_eq_u32 vcc, -1, v3
    s_cbranch_vccz ok_76
    buffer_load_dwordx4 v[56:59], v1, s[24:27], s74 offen sc1
ok_76:
    v_max3_u32 v3, v60, v61, v62
    v_max_u32 v3, v3, v63
    v_cmp_eq_u32 vcc, -1, v3
    s_cbranch_vccz ok_77
    buffer_load_dwordx4 v[60:63], v1, s[24:27], s75 offen sc1
ok_77:
    s_branch pa_67
pad_68:
    v_pk_add_f32 v[32:33], v[32:33], v[48:49]
    v_pk_add_f32 v[34:35], v[34:35], v[50:51]
    v_pk_add_f32 v[36:37], v[36:37], v[52:53]
    v_pk_add_f32 v[38:39], v[38:39], v[54:55]
    v_pk_add_f32 v[40:41], v[40:41], v[56:57]
    v_pk_add_f32 v[42:43], v[42:43], v[58:59]
    v_pk_add_f32 v[44:45], v[44:45], v[60:61]
    v_pk_add_f32 v[46:47], v[46:47], v[62:63]
    v_pk_add_f32 v[32:33], v[32:33], v[40:41]
    v_pk_add_f32 v[34:35], v[34:35], v[42:43]
    v_pk_add_f32 v[36:37], v[36:37], v[44:45]
    v_pk_add_f32 v[38:39], v[38:39], v[46:47]
    v_pk_add_f32 v[32:33], v[32:33], v[36:37]
    v_pk_add_f32 v[34:35], v[34:35], v[38:39]
    s_nop 1
    v_permlane32_swap_b32 v32, v34
    v_permlane32_swap_b32 v33, v35
    v_add_f32 v32, v32, v34
    v_add_f32 v33, v33, v35
    s_nop 1
    v_permlane16_swap_b32 v32, v33
    v_add_f32 v27, v32, v33
    v_cvt_pk_bf16_f32 v27, v27, v27
    v_lshlrev_b32 v27, 16, v27
    v_mul_f32 v27, v27, v23
    v_cvt_pk_bf16_f32 v27, v27, v27
    v_lshlrev_b32 v27, 16, v27
    v_add_f32 v27, v27, v24
    v_cvt_pk_bf16_f32 v27, v27, v27
    v_lshlrev_b32 v27, 16, v27
    ds_write_b32 v25, v27 offset:2304
    v_readfirstlane_b32 s30, v27
    s_nop 1
    v_subrev_f32 v28, s30, v27
    v_mul_f32 v29, v28, v28
    s_nop 1
    v_permlane32_swap_b32 v28, v29
    v_add_f32 v28, v28, v29
    s_nop 1
    v_add_f32_dpp v28, v28, v28 row_ror:1 row_mask:0xf bank_mask:0xf
    s_nop 1
    v_add_f32_dpp v28, v28, v28 row_ror:2 row_mask:0xf bank_mask:0xf
    s_nop 1
    v_add_f32_dpp v28, v28, v28 row_ror:4 row_mask:0xf bank_mask:0xf
    s_nop 1
    v_add_f32_dpp v28, v28, v28 row_ror:8 row_mask:0xf bank_mask:0xf
    v_mov_b32 v29, v28
    s_nop 1
    v_permlane16_swap_b32 v28, v29
    v_add_f32 v28, v28, v29
    ds_write_b32 v26, v28 offset:128
    s_waitcnt lgkmcnt(0)
    s_cbranch_execz g_78
    s_barrier
g_78:
    s_waitcnt vmcnt(0)
    v_perm_b32 v4, v100, v96, s64
    v_perm_b32 v100, v100, v96, s65
    v_mov_b32 v96, v4
    v_perm_b32 v4, v101, v97, s64
    v_perm_b32 v5, v101, v97, s65
    v_perm_b32 v97, v108, v104, s64
    v_perm_b32 v101, v108, v104, s65
    v_mov_b32 v104, v4
    v_mov_b32 v108, v5
    v_perm_b32 v4, v102, v98, s64
    v_perm_b32 v5, v102, v98, s65
    v_perm_b32 v98, v116, v112, s64
    v_perm_b32 v102, v116, v112, s65
    v_mov_b32 v112, v4
    v_mov_b32 v116, v5
    v_perm_b32 v4, v103, v99, s64
    v_perm_b32 v5, v103, v99, s65
    v_perm_b32 v99, v124, v120, s64
    v_perm_b32 v103, v124, v120, s65
    v_mov_b32 v120, v4
    v_mov_b32 v124, v5
    v_perm_b32 v4, v109, v105, s64
    v_perm_b32 v109, v109, v105, s65
    v_mov_b32 v105, v4
    v_perm_b32 v4, v110, v106, s64
    v_perm_b32 v5, v110, v106, s65
    v_perm_b32 v106, v117, v113, s64
    v_perm_b32 v110, v117, v113, s65
    v_mov_b32 v113, v4
    v_mov_b32 v117, v5
    v_perm_b32 v4, v111, v107, s64
    v_perm_b32 v5, v111, v107, s65
    v_perm_b32 v107, v125, v121, s64
    v_perm_b32 v111, v125, v121, s65
    v_mov_b32 v121, v4
    v_mov_b32 v125, v5
    v_perm_b32 v4, v118, v114, s64
    v_perm_b32 v118, v118, v114, s65
    v_mov_b32 v114, v4
    v_perm_b32 v4, v119, v115, s64
    v_perm_b32 v5, v119, v115, s65
    v_perm_b32 v115, v126, v122, s64
    v_perm_b32 v119, v126, v122, s65
    v_mov_b32 v122, v4
    v_mov_b32 v126, v5
    v_perm_b32 v4, v127, v123, s64
    v_perm_b32 v127, v127, v123, s65
    v_mov_b32 v123, v4
    s_cbranch_execz g_79
    s_barrier
g_79:
    ds_read2_b64 v[24:27], v12 offset0:0 offset1:8
    ds_read2_b64 v[28:31], v12 offset0:64 offset1:72
    s_waitcnt lgkmcnt(1)
    v_cvt_f32_f64 v24, v[24:25]
    v_cvt_f32_f64 v25, v[26:27]
    v_cvt_pk_bf16_f32 v3, v24, v25
    v_lshlrev_b32 v24, 16, v3
    v_and_b32 v25, s66, v3
    v_mul_f32 v24, 0xbfb8aa3b, v24
    v_mul_f32 v25, 0xbfb8aa3b, v25
    v_exp_f32 v24, v24
    v_exp_f32 v25, v25
    s_waitcnt lgkmcnt(0)
    v_cvt_f32_f64 v28, v[28:29]
    v_cvt_f32_f64 v29, v[30:31]
    v_cvt_pk_bf16_f32 v3, v28, v29
    v_add_f32 v24, 1.0, v24
    v_add_f32 v25, 1.0, v25
    v_rcp_f32 v24, v24
    v_rcp_f32 v25, v25
    v_lshlrev_b32 v28, 16, v3
    v_and_b32 v29, s66, v3
    v_cvt_pk_bf16_f32 v3, v24, v25
    v_lshlrev_b32 v24, 16, v3
    v_and_b32 v25, s66, v3
    v_mul_f32 v24, v24, v28
    v_mul_f32 v25, v25, v29
    v_cvt_pk_bf16_f32 v24, v24, v25
    s_nop 1
    v_mov_b32_dpp v25, v24 row_ror:14 row_mask:0xf bank_mask:0xf
    v_mov_b32_dpp v26, v24 row_ror:12 row_mask:0xf bank_mask:0xf
    v_mov_b32_dpp v27, v24 row_ror:10 row_mask:0xf bank_mask:0xf
    s_nop 1
    v_mfma_f32_16x16x32_bf16 v[96:99], v[24:27], v[96:99], 0
    v_mfma_f32_16x16x32_bf16 v[100:103], v[24:27], v[100:103], 0
    v_mfma_f32_16x16x32_bf16 v[104:107], v[24:27], v[104:107], 0
    v_mfma_f32_16x16x32_bf16 v[108:111], v[24:27], v[108:111], 0
    v_mfma_f32_16x16x32_bf16 v[112:115], v[24:27], v[112:115], 0
    v_mfma_f32_16x16x32_bf16 v[116:119], v[24:27], v[116:119], 0
    v_mfma_f32_16x16x32_bf16 v[120:123], v[24:27], v[120:123], 0
    v_mfma_f32_16x16x32_bf16 v[124:127], v[24:27], v[124:127], 0
    s_nop 0
    v_add_f32_dpp v28, v97, v96 row_ror:8 row_mask:0x1 bank_mask:0x3
    v_add_f32_dpp v29, v101, v100 row_ror:8 row_mask:0x1 bank_mask:0x3
    v_add_f32_dpp v30, v105, v104 row_ror:8 row_mask:0x1 bank_mask:0x3
    v_add_f32_dpp v31, v109, v108 row_ror:8 row_mask:0x1 bank_mask:0x3
    v_add_f32_dpp v28, v113, v112 row_ror:8 row_mask:0x4 bank_mask:0x3
    v_add_f32_dpp v29, v117, v116 row_ror:8 row_mask:0x4 bank_mask:0x3
    v_add_f32_dpp v30, v121, v120 row_ror:8 row_mask:0x4 bank_mask:0x3
    v_add_f32_dpp v31, v125, v124 row_ror:8 row_mask:0x4 bank_mask:0x3
    s_cbranch_execz g_80
    s_mov_b32 exec_lo, 0xff
    s_mov_b32 exec_hi, 0xff
    buffer_store_dwordx4 v[28:31], v11, s[24:27], s100 offen sc1
    s_mov_b64 exec, -1
g_80:
    s_cbranch_execz L_dry2
    s_endpgm
L_comm:
    v_mov_b32 v4, 0
    v_mov_b32 v5, 0
    v_mov_b32 v6, 0
    v_mov_b32 v7, 0
    v_lshlrev_b32 v1, 4, v0
    ds_write_b128 v1, v[4:7]
    ds_write_b128 v1, v[4:7] offset:1024
    ds_write_b128 v1, v[4:7] offset:2048
    s_setprio 3
    s_waitcnt lgkmcnt(0)
    s_barrier
    s_add_u32 s30, s6, 1
    s_and_b32 s30, s30, 3
    s_lshl_b32 s7, s4, 2
    s_add_u32 s7, s7, s30
    s_sub_u32 s7, s7, 4
    s_lshl_b32 s30, s4, 1
    s_add_u32 s30, s30, s6
    s_cmp_ge_u32 s4, 2
    s_cselect_b32 s7, s7, s30
    s_mov_b32 s24, s62
    s_mov_b32 s25, s63
    s_mov_b32 s26, 0x200000
    s_mov_b32 s27, 0x20000
    s_mov_b32 s30, 692224
    buffer_load_dword v12, v2, s[24:27], s30 offen sc1
    v_mov_b32 v4, -1
    v_mov_b32 v5, -1
    v_mov_b32 v6, -1
    v_mov_b32 v7, -1
    s_lshl_b32 s34, s5, 3
    s_add_u32 s34, s34, s4
    s_lshl_b32 s30, s34, 13
    s_lshl_b32 s31, s6, 11
    s_add_u32 s30, s30, s31
    s_add_u32 s30, s30, 131072
    buffer_store_dwordx4 v[4:7], v1, s[24:27], s30 offen sc1
    buffer_store_dwordx4 v[4:7], v1, s[24:27], s30 offen offset:1024 sc1
    s_lshl_b32 s30, s5, 5
    s_lshl_b32 s31, s4, 2
    s_add_u32 s30, s30, s31
    s_add_u32 s30, s30, s6
    s_mul_i32 s30, s30, 1792
    s_add_u32 s30, s30, 720896
    s_mul_i32 s31, s5, 28
    s_add_u32 s31, s31, s7
    s_mul_i32 s31, s31, 1792
    s_add_u32 s31, s31, 1179648
    s_cmp_eq_u32 s28, 2
    s_cselect_b32 s31, s30, s31
    buffer_store_dwordx4 v[4:7], v1, s[24:27], s30 offen sc1
    buffer_store_dwordx4 v[4:7], v1, s[24:27], s31 offen sc1
    s_mov_b32 exec_hi, 0xffff
    buffer_store_dwordx4 v[4:7], v1, s[24:27], s30 offen offset:1024 sc1
    buffer_store_dwordx4 v[4:7], v1, s[24:27], s31 offen offset:1024 sc1
    s_lshl_b32 s30, s34, 9
    s_lshl_b32 s31, s6, 7
    s_add_u32 s30, s30, s31
    s_add_u32 s30, s30, 655360
    s_mov_b64 exec, 0xff
    buffer_store_dwordx4 v[4:7], v1, s[24:27], s30 offen sc1
    s_mov_b64 exec, 1
    s_lshl_b32 s30, s5, 5
    s_lshl_b32 s31, s4, 2
    s_add_u32 s30, s30, s31
    s_add_u32 s30, s30, s6
    s_lshl_b32 s30, s30, 2
    s_add_u32 s30, s30, 688128
    s_cmp_eq_u32 s79, 0
    s_cbranch_scc1 L_c_cert
spin_81:
    ds_read_b32 v3, v2 offset:28
    s_waitcnt lgkmcnt(0)
    v_readfirstlane_b32 s31, v3
    s_nop 0
    s_cmp_ge_u32 s31, 7
    s_cbranch_scc1 spind_82
    s_sleep 1
    s_branch spin_81
spind_82:
L_c_cert:
    s_waitcnt vmcnt(0)
    v_readfirstlane_b32 s78, v12
    s_nop 0
    s_add_u32 s78, s78, 0x9e3779b9
    v_mov_b32 v3, 1
    ds_write_b32 v2, v3 offset:56
    v_mov_b32 v3, s78
    buffer_store_dword v3, v2, s[24:27], s30 offen sc1
    s_mov_b64 exec, -1
    s_lshl_b32 s30, s5, 13
    s_lshl_b32 s31, s4, 10
    s_add_u32 s30, s30, s31
    s_add_u32 s30, s30, 65536
    s_add_u32 s34, s62, s30
    s_addc_u32 s35, s63, 0
    s_add_u32 s100, s34, 1638400
    s_addc_u32 s101, s35, 0
    s_mov_b32 s33, 0
sp_83:
    s_mov_b32 s31, 0
    s_load_dword s8, s[34:35], 0x180 glc
    s_load_dword s9, s[100:101], 0x180 glc
    s_waitcnt lgkmcnt(0)
    s_xor_b32 s30, s8, s9
    s_xor_b32 s30, s30, s78
    s_or_b32 s31, s31, s30
    s_cmp_eq_u32 s31, 0
    s_cbranch_scc1 spd_84
    s_add_u32 s33, s33, 1
    s_cmp_lt_u32 s33, 256
    s_cbranch_scc1 sp_83
spd_84:
    s_lshl_b32 s30, s5, 13
    s_lshl_b32 s31, s4, 10
    s_add_u32 s30, s30, s31
    s_add_u32 s30, s30, 65536
    s_add_u32 s34, s62, s30
    s_addc_u32 s35, s63, 0
    s_add_u32 s100, s34, 1638400
    s_addc_u32 s101, s35, 0
    s_mov_b32 s33, 0
sp_85:
    s_mov_b32 s31, 0
    s_load_dword s8, s[34:35], 0x0 glc
    s_load_dword s9, s[100:101], 0x0 glc
    s_load_dword s10, s[34:35], 0x80 glc
    s_load_dword s11, s[100:101], 0x80 glc
    s_load_dword s12, s[34:35], 0x100 glc
    s_load_dword s13, s[100:101], 0x100 glc
    s_load_dword s14, s[34:35], 0x180 glc
    s_load_dword s15, s[100:101], 0x180 glc
    s_load_dword s16, s[34:35], 0x200 glc
    s_load_dword s17, s[100:101], 0x200 glc
    s_load_dword s18, s[34:35], 0x280 glc
    s_load_dword s19, s[100:101], 0x280 glc
    s_load_dword s20, s[34:35], 0x300 glc
    s_load_dword s21, s[100:101], 0x300 glc
    s_load_dword s22, s[34:35], 0x380 glc
    s_load_dword s23, s[100:101], 0x380 glc
    s_waitcnt lgkmcnt(0)
    s_xor_b32 s30, s8, s9
    s_xor_b32 s30, s30, s78
    s_or_b32 s31, s31, s30
    s_xor_b32 s30, s10, s11
    s_xor_b32 s30, s30, s78
    s_or_b32 s31, s31, s30
    s_xor_b32 s30, s12, s13
    s_xor_b32 s30, s30, s78
    s_or_b32 s31, s31, s30
    s_xor_b32 s30, s14, s15
    s_xor_b32 s30, s30, s78
    s_or_b32 s31, s31, s30
    s_xor_b32 s30, s16, s17
    s_xor_b32 s30, s30, s78
    s_or_b32 s31, s31, s30
    s_xor_b32 s30, s18, s19
    s_xor_b32 s30, s30, s78
    s_or_b32 s31, s31, s30
    s_xor_b32 s30, s20, s21
    s_xor_b32 s30, s30, s78
    s_or_b32 s31, s31, s30
    s_xor_b32 s30, s22, s23
    s_xor_b32 s30, s30, s78
    s_or_b32 s31, s31, s30
    s_cmp_eq_u32 s31, 0
    s_cbranch_scc1 spd_86
    s_add_u32 s33, s33, 1
    s_cmp_lt_u32 s33, 256
    s_cbranch_scc1 sp_85
spd_86:
    s_lshl_b32 s30, s5, 13
    s_lshl_b32 s31, s4, 10
    s_add_u32 s30, s30, s31
    s_add_u32 s30, s30, 65536
    s_add_u32 s32, s30, 1638400
    s_mov_b32 s33, 0
pollx_87:
    buffer_load_dwordx4 v[12:15], v1, s[24:27], s30 offen sc1
    buffer_load_dwordx4 v[16:19], v1, s[24:27], s32 offen sc1
    s_waitcnt vmcnt(0)
    v_xor_b32 v16, v12, v16
    v_xor_b32 v16, s78, v16
    v_xor_b32 v17, v13, v17
    v_xor_b32 v17, s78, v17
    v_or_b32 v16, v16, v17
    v_xor_b32 v18, v14, v18
    v_xor_b32 v18, s78, v18
    v_or_b32 v16, v16, v18
    v_xor_b32 v19, v15, v19
    v_xor_b32 v19, s78, v19
    v_or_b32 v16, v16, v19
    v_cmp_ne_u32 vcc, 0, v16
    s_cbranch_vccz pollxd_88
    s_add_u32 s33, s33, 1
    s_cmp_lt_u32 s33, 1048576
    s_cbranch_scc1 pollx_87
pollxd_88:
    ds_write_b128 v1, v[12:15] offset:4096
    v_mov_b32 v3, 1
    s_waitcnt lgkmcnt(0)
    ds_write_b32 v2, v3 offset:0
    v_and_b32 v3, 7, v0
    v_lshlrev_b32 v3, 4, v3
    s_lshl_b32 s30, s5, 7
    v_add_u32 v3, s30, v3
    s_cmp_eq_u32 s2, 0
    s_cselect_b64 vcc, -1, 0
    v_cndmask_b32 v10, v3, v1, vcc
    v_mov_b32 v16, 0
    s_mov_b32 s30, 688128
    s_mov_b32 s33, 0
cert_89:
    buffer_load_dwordx4 v[12:15], v10, s[24:27], s30 offen sc1
    s_waitcnt vmcnt(0)
    v_xor_b32 v12, s78, v12
    v_xor_b32 v13, s78, v13
    v_xor_b32 v14, s78, v14
    v_xor_b32 v15, s78, v15
    v_or3_b32 v12, v12, v13, v14
    v_or_b32 v12, v12, v15
    v_cmp_ne_u32 vcc, 0, v12
    s_cbranch_vccz certd_90
    s_add_u32 s33, s33, 1
    s_cmp_lt_u32 s33, 1048576
    s_cbranch_scc1 cert_89
certd_90:
    s_cmp_lg_u32 s2, 0
    s_cbranch_scc1 L_c_notag
    v_mov_b32 v3, s78
    s_mov_b32 s30, 692224
    s_mov_b64 exec, 1
    buffer_store_dword v3, v2, s[24:27], s30 offen sc1
    s_mov_b64 exec, -1
L_c_notag:
    s_mov_b64 exec, 0
    s_branch L_st_tail
L_dry2:
    s_branch L_final
L_dry3:
    s_nop 7
    s_mov_b64 exec, -1
spin_91:
    ds_read_b32 v3, v2 offset:64
    s_waitcnt lgkmcnt(0)
    v_readfirstlane_b32 s30, v3
    s_nop 0
    s_cmp_ge_u32 s30, 8
    s_cbranch_scc1 spind_92
    s_sleep 1
    s_branch spin_91
spind_92:
    s_lshl_b32 s34, s5, 3
    s_add_u32 s34, s34, s4
    s_lshl_b32 s30, s34, 13
    s_add_u32 s30, s30, 131072
    s_add_u32 s32, s30, 4096
    s_lshl_b32 s35, s34, 9
    s_add_u32 s35, s35, 655360
    v_and_b32 v3, 31, v0
    v_lshlrev_b32 v8, 4, v3
    s_mov_b32 s33, 0
poll_93:
    buffer_load_dwordx4 v[12:15], v8, s[24:27], s35 offen sc1
    buffer_load_dwordx4 v[32:35], v1, s[24:27], s30 offen offset:0 sc1
    buffer_load_dwordx4 v[36:39], v1, s[24:27], s30 offen offset:1024 sc1
    buffer_load_dwordx4 v[40:43], v1, s[24:27], s30 offen offset:2048 sc1
    buffer_load_dwordx4 v[44:47], v1, s[24:27], s30 offen offset:3072 sc1
    buffer_load_dwordx4 v[48:51], v1, s[24:27], s32 offen offset:0 sc1
    buffer_load_dwordx4 v[52:55], v1, s[24:27], s32 offen offset:1024 sc1
    buffer_load_dwordx4 v[56:59], v1, s[24:27], s32 offen offset:2048 sc1
    buffer_load_dwordx4 v[60:63], v1, s[24:27], s32 offen offset:3072 sc1
    s_waitcnt vmcnt(0)
    v_max3_u32 v3, v12, v13, v14
    v_max3_u32 v3, v3, v15, v32
    v_max3_u32 v3, v3, v33, v34
    v_max3_u32 v3, v3, v35, v36
    v_max3_u32 v3, v3, v37, v38
    v_max3_u32 v3, v3, v39, v40
    v_max3_u32 v3, v3, v41, v42
    v_max3_u32 v3, v3, v43, v44
    v_max3_u32 v3, v3, v45, v46
    v_max3_u32 v3, v3, v47, v48
    v_max3_u32 v3, v3, v49, v50
    v_max3_u32 v3, v3, v51, v52
    v_max3_u32 v3, v3, v53, v54
    v_max3_u32 v3, v3, v55, v56
    v_max3_u32 v3, v3, v57, v58
    v_max3_u32 v3, v3, v59, v60
    v_max3_u32 v3, v3, v61, v62
    v_max_u32 v3, v3, v63
    v_cmp_eq_u32 vcc, -1, v3
    s_cbranch_vccz polld_94
    s_add_u32 s33, s33, 1
    s_cmp_lt_u32 s33, 1048576
    s_cbranch_scc1 poll_93
polld_94:
    ds_write_b128 v1, v[32:35] offset:10240
    ds_write_b128 v1, v[36:39] offset:11264
    ds_write_b128 v1, v[40:43] offset:12288
    ds_write_b128 v1, v[44:47] offset:13312
    ds_write_b128 v1, v[48:51] offset:14336
    ds_write_b128 v1, v[52:55] offset:15360
    ds_write_b128 v1, v[56:59] offset:16384
    ds_write_b128 v1, v[60:63] offset:17408
    v_mov_b32 v16, v12
    v_mov_b32 v18, v14
    s_nop 0
    v_max_f32_dpp v16, v16, v16 row_ror:1 row_mask:0xf bank_mask:0xf
    v_max_f32_dpp v18, v18, v18 row_ror:1 row_mask:0xf bank_mask:0xf
    s_nop 0
    v_max_f32_dpp v16, v16, v16 row_ror:2 row_mask:0xf bank_mask:0xf
    v_max_f32_dpp v18, v18, v18 row_ror:2 row_mask:0xf bank_mask:0xf
    s_nop 0
    v_max_f32_dpp v16, v16, v16 row_ror:4 row_mask:0xf bank_mask:0xf
    v_max_f32_dpp v18, v18, v18 row_ror:4 row_mask:0xf bank_mask:0xf
    s_nop 0
    v_max_f32_dpp v16, v16, v16 row_ror:8 row_mask:0xf bank_mask:0xf
    v_max_f32_dpp v18, v18, v18 row_ror:8 row_mask:0xf bank_mask:0xf
    v_mov_b32 v3, v16
    s_nop 1
    v_permlane16_swap_b32 v3, v16
    v_max_f32 v16, v16, v3
    v_mov_b32 v4, v18
    s_nop 1
    v_permlane16_swap_b32 v4, v18
    v_max_f32 v18, v18, v4
    v_sub_f32 v12, v12, v16
    v_sub_f32 v14, v14, v18
    v_mul_f32 v12, s67, v12
    v_mul_f32 v14, s67, v14
    v_exp_f32 v12, v12
    v_exp_f32 v14, v14
    v_mul_f32 v17, v12, v13
    v_mul_f32 v19, v14, v15
    s_nop 0
    v_add_f32_dpp v17, v17, v17 row_ror:1 row_mask:0xf bank_mask:0xf
    v_add_f32_dpp v19, v19, v19 row_ror:1 row_mask:0xf bank_mask:0xf
    s_nop 0
    v_add_f32_dpp v17, v17, v17 row_ror:2 row_mask:0xf bank_mask:0xf
    v_add_f32_dpp v19, v19, v19 row_ror:2 row_mask:0xf bank_mask:0xf
    s_nop 0
    v_add_f32_dpp v17, v17, v17 row_ror:4 row_mask:0xf bank_mask:0xf
    v_add_f32_dpp v19, v19, v19 row_ror:4 row_mask:0xf bank_mask:0xf
    s_nop 0
    v_add_f32_dpp v17, v17, v17 row_ror:8 row_mask:0xf bank_mask:0xf
    v_add_f32_dpp v19, v19, v19 row_ror:8 row_mask:0xf bank_mask:0xf
    v_mov_b32 v3, v17
    s_nop 1
    v_permlane16_swap_b32 v3, v17
    v_add_f32 v17, v17, v3
    v_mov_b32 v4, v19
    s_nop 1
    v_permlane16_swap_b32 v4, v19
    v_add_f32 v19, v19, v4
    v_rcp_f32 v17, v17
    v_rcp_f32 v19, v19
    v_mul_f32 v16, s67, v16
    v_mul_f32 v18, s67, v18
    v_mov_b32 v3, 1
    ds_write_b128 v2, v[16:19] offset:32
    s_waitcnt lgkmcnt(0)
    ds_write_b32 v2, v3 offset:4
    s_cmp_eq_u32 s28, 2
    s_cbranch_scc1 L_c_nomodg
    s_mov_b32 s96, s36
    s_mov_b32 s97, s37
    s_mov_b32 s98, 7168
    s_mov_b32 s99, 0x20000
    s_mul_i32 s30, s5, 896
    s_mov_b32 exec_hi, 0xffffff
    buffer_load_dwordx4 v[28:31], v1, s[96:99], s30 offen
    s_mov_b32 exec_hi, -1
    s_mul_i32 s30, s5, 5376
    s_add_u32 s30, s30, 1792
    s_add_u32 s32, s30, 1638400
    v_and_b32 v3, 31, v0
    v_lshlrev_b32 v8, 4, v3
    s_mov_b32 s33, 0
pollx_95:
    buffer_load_dwordx4 v[12:15], v1, s[24:27], s30 offen offset:0 sc1
    buffer_load_dwordx4 v[16:19], v1, s[24:27], s30 offen offset:1024 sc1
    buffer_load_dwordx4 v[20:23], v1, s[24:27], s30 offen offset:2048 sc1
    buffer_load_dwordx4 v[24:27], v8, s[24:27], s30 offen offset:3072 sc1
    buffer_load_dwordx4 v[32:35], v1, s[24:27], s32 offen offset:0 sc1
    buffer_load_dwordx4 v[36:39], v1, s[24:27], s32 offen offset:1024 sc1
    buffer_load_dwordx4 v[40:43], v1, s[24:27], s32 offen offset:2048 sc1
    buffer_load_dwordx4 v[44:47], v8, s[24:27], s32 offen offset:3072 sc1
    s_waitcnt vmcnt(0)
    v_xor_b32 v32, v12, v32
    v_xor_b32 v32, s78, v32
    v_xor_b32 v33, v13, v33
    v_xor_b32 v33, s78, v33
    v_or_b32 v32, v32, v33
    v_xor_b32 v34, v14, v34
    v_xor_b32 v34, s78, v34
    v_or_b32 v32, v32, v34
    v_xor_b32 v35, v15, v35
    v_xor_b32 v35, s78, v35
    v_or_b32 v32, v32, v35
    v_xor_b32 v36, v16, v36
    v_xor_b32 v36, s78, v36
    v_or_b32 v32, v32, v36
    v_xor_b32 v37, v17, v37
    v_xor_b32 v37, s78, v37
    v_or_b32 v32, v32, v37
    v_xor_b32 v38, v18, v38
    v_xor_b32 v38, s78, v38
    v_or_b32 v32, v32, v38
    v_xor_b32 v39, v19, v39
    v_xor_b32 v39, s78, v39
    v_or_b32 v32, v32, v39
    v_xor_b32 v40, v20, v40
    v_xor_b32 v40, s78, v40
    v_or_b32 v32, v32, v40
    v_xor_b32 v41, v21, v41
    v_xor_b32 v41, s78, v41
    v_or_b32 v32, v32, v41
    v_xor_b32 v42, v22, v42
    v_xor_b32 v42, s78, v42
    v_or_b32 v32, v32, v42
    v_xor_b32 v43, v23, v43
    v_xor_b32 v43, s78, v43
    v_or_b32 v32, v32, v43
    v_xor_b32 v44, v24, v44
    v_xor_b32 v44, s78, v44
    v_or_b32 v32, v32, v44
    v_xor_b32 v45, v25, v45
    v_xor_b32 v45, s78, v45
    v_or_b32 v32, v32, v45
    v_xor_b32 v46, v26, v46
    v_xor_b32 v46, s78, v46
    v_or_b32 v32, v32, v46
    v_xor_b32 v47, v27, v47
    v_xor_b32 v47, s78, v47
    v_or_b32 v32, v32, v47
    v_cmp_ne_u32 vcc, 0, v32
    s_cbranch_vccz pollxd_96
    s_add_u32 s33, s33, 1
    s_cmp_lt_u32 s33, 1048576
    s_cbranch_scc1 pollx_95
pollxd_96:
    ds_write_b128 v1, v[12:15] offset:5120
    ds_write_b128 v1, v[16:19] offset:6144
    ds_write_b128 v1, v[20:23] offset:7168
    ds_write_b128 v8, v[24:27] offset:8192
    s_mov_b32 exec_hi, 0xffffff
    ds_write_b128 v1, v[28:31] offset:8704
    s_mov_b32 exec_hi, -1
L_c_nomodg:
L_c_skip:
    s_mul_i32 s30, s5, 50176
    s_lshl_b32 s31, s7, 6
    s_add_u32 s30, s30, s31
    s_add_u32 s68, s30, 1179648
    s_add_u32 s69, s68, 3584
    s_add_u32 s70, s68, 7168
    s_add_u32 s71, s68, 10752
    v_lshrrev_b32 v3, 4, v0
    v_mul_u32_u24 v3, 12544, v3
    v_and_b32 v4, 15, v0
    v_lshl_add_u32 v8, v4, 2, v3
    s_lshl_b32 s30, s7, 4
    v_add_u32 v9, s30, v4
    v_lshlrev_b32 v10, 2, v9
    v_lshlrev_b32 v9, 1, v9
    s_mul_i32 s72, s5, 896
    s_mov_b32 s96, s58
    s_mov_b32 s97, s59
    s_mov_b32 s98, 7168
    s_mov_b32 s99, 0x20000
    s_cmp_eq_u32 s28, 2
    s_cbranch_scc1 L_st_end
    s_mov_b32 s16, s48
    s_mov_b32 s17, s49
    s_mov_b32 s18, 1605632
    s_mov_b32 s19, 0x20000
    v_lshrrev_b32 v3, 3, v0
    v_mul_u32_u24 v3, 28672, v3
    v_and_b32 v11, 7, v0
    v_lshl_add_u32 v11, v11, 4, v3
    s_lshl_b32 s34, s7, 7
    s_mov_b32 s35, 32768
spin_97:
    ds_read_b32 v3, v2 offset:68
    s_waitcnt lgkmcnt(0)
    v_readfirstlane_b32 s30, v3
    s_nop 0
    s_cmp_ge_u32 s30, 8
    s_cbranch_scc1 spind_98
    s_sleep 1
    s_branch spin_97
spind_98:
    s_add_u32 m0, s35, 0
    s_nop 0
    buffer_load_dwordx4 v11, s[16:19], s34 offen  lds
    s_add_u32 s34, s34, 3584
    s_add_u32 m0, s35, 1024
    s_nop 0
    buffer_load_dwordx4 v11, s[16:19], s34 offen  lds
    s_add_u32 s34, s34, 3584
    s_add_u32 m0, s35, 2048
    s_nop 0
    buffer_load_dwordx4 v11, s[16:19], s34 offen  lds
    s_add_u32 s34, s34, 3584
    s_add_u32 m0, s35, 3072
    s_nop 0
    buffer_load_dwordx4 v11, s[16:19], s34 offen  lds
    s_add_u32 s34, s34, 3584
    s_add_u32 m0, s35, 4096
    s_nop 0
    buffer_load_dwordx4 v11, s[16:19], s34 offen  lds
    s_add_u32 s34, s34, 3584
    s_add_u32 m0, s35, 5120
    s_nop 0
    buffer_load_dwordx4 v11, s[16:19], s34 offen  lds
    s_add_u32 s34, s34, 3584
    s_add_u32 m0, s35, 6144
    s_nop 0
    buffer_load_dwordx4 v11, s[16:19], s34 offen  lds
    s_add_u32 s34, s34, 3584
    s_add_u32 m0, s35, 7168
    s_nop 0
    buffer_load_dwordx4 v11, s[16:19], s34 offen  lds
    s_add_u32 s34, s34, 204288
    s_add_u32 s35, s35, 8192
    s_add_u32 m0, s35, 0
    s_nop 0
    buffer_load_dwordx4 v11, s[16:19], s34 offen  lds
    s_add_u32 s34, s34, 3584
    s_add_u32 m0, s35, 1024
    s_nop 0
    buffer_load_dwordx4 v11, s[16:19], s34 offen  lds
    s_add_u32 s34, s34, 3584
    s_add_u32 m0, s35, 2048
    s_nop 0
    buffer_load_dwordx4 v11, s[16:19], s34 offen  lds
    s_add_u32 s34, s34, 3584
    s_add_u32 m0, s35, 3072
    s_nop 0
    buffer_load_dwordx4 v11, s[16:19], s34 offen  lds
    s_add_u32 s34, s34, 3584
    s_add_u32 m0, s35, 4096
    s_nop 0
    buffer_load_dwordx4 v11, s[16:19], s34 offen  lds
    s_add_u32 s34, s34, 3584
    s_add_u32 m0, s35, 5120
    s_nop 0
    buffer_load_dwordx4 v11, s[16:19], s34 offen  lds
    s_add_u32 s34, s34, 3584
    s_add_u32 m0, s35, 6144
    s_nop 0
    buffer_load_dwordx4 v11, s[16:19], s34 offen  lds
    s_add_u32 s34, s34, 3584
    s_add_u32 m0, s35, 7168
    s_nop 0
    buffer_load_dwordx4 v11, s[16:19], s34 offen  lds
    s_add_u32 s34, s34, 204288
    s_add_u32 s35, s35, 8192
    s_add_u32 m0, s35, 0
    s_nop 0
    buffer_load_dwordx4 v11, s[16:19], s34 offen  lds
    s_add_u32 s34, s34, 3584
    s_add_u32 m0, s35, 1024
    s_nop 0
    buffer_load_dwordx4 v11, s[16:19], s34 offen  lds
    s_add_u32 s34, s34, 3584
    s_add_u32 m0, s35, 2048
    s_nop 0
    buffer_load_dwordx4 v11, s[16:19], s34 offen  lds
    s_add_u32 s34, s34, 3584
    s_add_u32 m0, s35, 3072
    s_nop 0
    buffer_load_dwordx4 v11, s[16:19], s34 offen  lds
    s_add_u32 s34, s34, 3584
    s_add_u32 m0, s35, 4096
    s_nop 0
    buffer_load_dwordx4 v11, s[16:19], s34 offen  lds
    s_add_u32 s34, s34, 3584
    s_add_u32 m0, s35, 5120
    s_nop 0
    buffer_load_dwordx4 v11, s[16:19], s34 offen  lds
    s_add_u32 s34, s34, 3584
    s_add_u32 m0, s35, 6144
    s_nop 0
    buffer_load_dwordx4 v11, s[16:19], s34 offen  lds
    s_add_u32 s34, s34, 3584
    s_add_u32 m0, s35, 7168
    s_nop 0
    buffer_load_dwordx4 v11, s[16:19], s34 offen  lds
    s_add_u32 s34, s34, 204288
    s_add_u32 s35, s35, 8192
    s_add_u32 m0, s35, 0
    s_nop 0
    buffer_load_dwordx4 v11, s[16:19], s34 offen  lds
    s_add_u32 s34, s34, 3584
    s_add_u32 m0, s35, 1024
    s_nop 0
    buffer_load_dwordx4 v11, s[16:19], s34 offen  lds
    s_add_u32 s34, s34, 3584
    s_add_u32 m0, s35, 2048
    s_nop 0
    buffer_load_dwordx4 v11, s[16:19], s34 offen  lds
    s_add_u32 s34, s34, 3584
    s_add_u32 m0, s35, 3072
    s_nop 0
    buffer_load_dwordx4 v11, s[16:19], s34 offen  lds
    s_add_u32 s34, s34, 3584
    s_add_u32 m0, s35, 4096
    s_nop 0
    buffer_load_dwordx4 v11, s[16:19], s34 offen  lds
    s_add_u32 s34, s34, 3584
    s_add_u32 m0, s35, 5120
    s_nop 0
    buffer_load_dwordx4 v11, s[16:19], s34 offen  lds
    s_add_u32 s34, s34, 3584
    s_add_u32 m0, s35, 6144
    s_nop 0
    buffer_load_dwordx4 v11, s[16:19], s34 offen  lds
    s_add_u32 s34, s34, 3584
    s_add_u32 m0, s35, 7168
    s_nop 0
    buffer_load_dwordx4 v11, s[16:19], s34 offen  lds
    s_add_u32 s34, s34, 204288
    s_add_u32 s35, s35, 8192
    s_add_u32 m0, s35, 0
    s_nop 0
    buffer_load_dwordx4 v11, s[16:19], s34 offen  lds
    s_add_u32 s34, s34, 3584
    s_add_u32 m0, s35, 1024
    s_nop 0
    buffer_load_dwordx4 v11, s[16:19], s34 offen  lds
    s_add_u32 s34, s34, 3584
    s_add_u32 m0, s35, 2048
    s_nop 0
    buffer_load_dwordx4 v11, s[16:19], s34 offen  lds
    s_add_u32 s34, s34, 3584
    s_add_u32 m0, s35, 3072
    s_nop 0
    buffer_load_dwordx4 v11, s[16:19], s34 offen  lds
    s_add_u32 s34, s34, 3584
    s_add_u32 m0, s35, 4096
    s_nop 0
    buffer_load_dwordx4 v11, s[16:19], s34 offen  lds
    s_add_u32 s34, s34, 3584
    s_add_u32 m0, s35, 5120
    s_nop 0
    buffer_load_dwordx4 v11, s[16:19], s34 offen  lds
    s_add_u32 s34, s34, 3584
    s_add_u32 m0, s35, 6144
    s_nop 0
    buffer_load_dwordx4 v11, s[16:19], s34 offen  lds
    s_add_u32 s34, s34, 3584
    s_add_u32 m0, s35, 7168
    s_nop 0
    buffer_load_dwordx4 v11, s[16:19], s34 offen  lds
    s_add_u32 s34, s34, 204288
    s_add_u32 s35, s35, 8192
    s_add_u32 m0, s35, 0
    s_nop 0
    buffer_load_dwordx4 v11, s[16:19], s34 offen  lds
    s_add_u32 s34, s34, 3584
    s_add_u32 m0, s35, 1024
    s_nop 0
    buffer_load_dwordx4 v11, s[16:19], s34 offen  lds
    s_add_u32 s34, s34, 3584
    s_add_u32 m0, s35, 2048
    s_nop 0
    buffer_load_dwordx4 v11, s[16:19], s34 offen  lds
    s_add_u32 s34, s34, 3584
    s_add_u32 m0, s35, 3072
    s_nop 0
    buffer_load_dwordx4 v11, s[16:19], s34 offen  lds
    s_add_u32 s34, s34, 3584
    s_add_u32 m0, s35, 4096
    s_nop 0
    buffer_load_dwordx4 v11, s[16:19], s34 offen  lds
    s_add_u32 s34, s34, 3584
    s_add_u32 m0, s35, 5120
    s_nop 0
    buffer_load_dwordx4 v11, s[16:19], s34 offen  lds
    s_add_u32 s34, s34, 3584
    s_add_u32 m0, s35, 6144
    s_nop 0
    buffer_load_dwordx4 v11, s[16:19], s34 offen  lds
    s_add_u32 s34, s34, 3584
    s_add_u32 m0, s35, 7168
    s_nop 0
    buffer_load_dwordx4 v11, s[16:19], s34 offen  lds
    s_add_u32 s34, s34, 204288
    s_add_u32 s35, s35, 8192
    s_add_u32 m0, s35, 0
    s_nop 0
    buffer_load_dwordx4 v11, s[16:19], s34 offen  lds
    s_add_u32 s34, s34, 3584
    s_add_u32 m0, s35, 1024
    s_nop 0
    buffer_load_dwordx4 v11, s[16:19], s34 offen  lds
    s_add_u32 s34, s34, 3584
    s_add_u32 m0, s35, 2048
    s_nop 0
    buffer_load_dwordx4 v11, s[16:19], s34 offen  lds
    s_add_u32 s34, s34, 3584
    s_add_u32 m0, s35, 3072
    s_nop 0
    buffer_load_dwordx4 v11, s[16:19], s34 offen  lds
    s_add_u32 s34, s34, 3584
    s_add_u32 m0, s35, 4096
    s_nop 0
    buffer_load_dwordx4 v11, s[16:19], s34 offen  lds
    s_add_u32 s34, s34, 3584
    s_add_u32 m0, s35, 5120
    s_nop 0
    buffer_load_dwordx4 v11, s[16:19], s34 offen  lds
    s_add_u32 s34, s34, 3584
    s_add_u32 m0, s35, 6144
    s_nop 0
    buffer_load_dwordx4 v11, s[16:19], s34 offen  lds
    s_add_u32 s34, s34, 3584
    s_add_u32 m0, s35, 7168
    s_nop 0
    buffer_load_dwordx4 v11, s[16:19], s34 offen  lds
    s_waitcnt vmcnt(0)
    s_waitcnt lgkmcnt(0)
    s_barrier
    s_barrier
    ds_read_b32 v20, v10 offset:2304
    ds_read_u16 v21, v9 offset:7808
    s_waitcnt lgkmcnt(0)
    v_lshlrev_b32 v21, 16, v21
    s_barrier
L_final:
    s_mov_b32 s33, 0
pd_99:
    s_cbranch_execz g_101
    buffer_load_dword v12, v8, s[24:27], s68 offen offset:0 sc1
    buffer_load_dword v13, v8, s[24:27], s68 offen offset:1792 sc1
    buffer_load_dword v14, v8, s[24:27], s69 offen offset:0 sc1
    buffer_load_dword v15, v8, s[24:27], s69 offen offset:1792 sc1
    buffer_load_dword v16, v8, s[24:27], s70 offen offset:0 sc1
    buffer_load_dword v17, v8, s[24:27], s70 offen offset:1792 sc1
    buffer_load_dword v18, v8, s[24:27], s71 offen offset:0 sc1
g_101:
    s_waitcnt vmcnt(0)
    v_max3_u32 v3, v12, v13, v14
    v_max3_u32 v3, v3, v15, v16
    v_max3_u32 v3, v3, v17, v18
    v_cmp_eq_u32 vcc, -1, v3
    s_cbranch_vccz pdd_100
    s_add_u32 s33, s33, 1
    s_cmp_lt_u32 s33, 1048576
    s_cbranch_scc1 pd_99
pdd_100:
    v_add_f32 v12, v12, v13
    v_add_f32 v14, v14, v15
    v_add_f32 v16, v16, v17
    v_add_f32 v12, v12, v18
    v_add_f32 v14, v14, v16
    v_add_f32 v12, v12, v14
    v_mov_b32 v3, v12
    s_nop 1
    v_permlane16_swap_b32 v3, v12
    v_add_f32 v12, v12, v3
    v_mov_b32 v3, v12
    s_nop 1
    v_permlane32_swap_b32 v3, v12
    v_add_f32 v12, v12, v3
    v_cvt_pk_bf16_f32 v12, v12, v12
    v_lshlrev_b32 v12, 16, v12
    v_mul_f32 v12, v12, v21
    v_cvt_pk_bf16_f32 v12, v12, v12
    v_lshlrev_b32 v12, 16, v12
    v_add_f32 v12, v12, v20
    v_cvt_pk_bf16_f32 v12, v12, v12
    s_cbranch_execz g_102
    s_mov_b64 exec, 0xffff
    buffer_store_short v12, v9, s[96:99], s72 offen
g_102:
    s_cbranch_execz L_dry3
L_end:
    s_endpgm
.section .rodata,"a"
.p2align 6
.amdhsa_kernel adaLN_cond__sliding_block_cached__glu_gated_glu__decode_kernel
  .amdhsa_next_free_vgpr 128
  .amdhsa_next_free_sgpr 102
  .amdhsa_accum_offset 128
  .amdhsa_group_segment_fixed_size 0
  .amdhsa_kernarg_size 112
  .amdhsa_user_sgpr_count 2
  .amdhsa_user_sgpr_kernarg_segment_ptr 1
  .amdhsa_system_sgpr_workgroup_id_x 1
  .amdhsa_float_denorm_mode_32 3
.end_amdhsa_kernel
```
